```python
import torch

def _softmax(x, axis=-1):
    return torch.softmax(x, dim=axis)
def _gelu(x):
    return torch.nn.functional.gelu(x, approximate="tanh")
def _silu(x):
    return torch.nn.functional.silu(x)
def _sigmoid(x):
    return torch.sigmoid(x)
def _layernorm(x, axis=-1, eps=1e-5):
    m = x.mean(dim=axis, keepdim=True)
    v = x.var(dim=axis, keepdim=True, unbiased=False)
    return (x - m) / torch.sqrt(v + eps)
def _scatter_add(tgt, idx, src, axis=0):
    return tgt.clone().index_add_(axis, idx, src)
def _segment_sum(src, seg, n):
    out = torch.zeros((n,) + src.shape[1:], dtype=src.dtype)
    return out.index_add_(0, seg, src)
def _pad(x, pw):
    flat = tuple(v for pair in reversed(pw) for v in pair)
    return torch.nn.functional.pad(x, flat)

kernel_name = 'standalone__mha_block_cached__sampling'

def setup_inputs():

    _w = (lambda a: (lambda t: t.to(torch.bfloat16) if t.is_floating_point() else t)(torch.as_tensor(a)))
    B, Sq, D = 8, 1, 640
    H, Sk, Dh = 32, 4096, 192
    return {
        "x": _w((lambda *s: torch.randn(*s, dtype=torch.bfloat16) * 0.8)(B, Sq, D)),
        "k_cache": _w((lambda *s: torch.randn(*s, dtype=torch.bfloat16) * 0.8)(B, H, Sk, Dh)),
        "v_cache": _w((lambda *s: torch.randn(*s, dtype=torch.bfloat16) * 0.05)(B, H, Sk, Dh)),
        "wq": _w((lambda *s: torch.randn(*s, dtype=torch.bfloat16) * 0.8)(D, H * Dh) * (D ** -0.5)),
        "wo": _w((lambda *s: torch.randn(*s, dtype=torch.bfloat16) * 0.05)(H * Dh, D) * ((H * Dh) ** -0.5)),
    }

def reference(x, k_cache, v_cache, wq, wo):
    B, Sq, D = x.shape
    H, Dh = 32, 192
    q = (lambda x, *d: x.permute(*d))((x @ wq).reshape(B, Sq, H, Dh), 0, 2, 1, 3)
    scores = torch.einsum("bhqd,bhkd->bhqk", q, k_cache) * (Dh ** -0.5)
    p = _softmax(scores, axis=-1)
    o = torch.einsum("bhqk,bhkd->bhqd", p, v_cache)
    return (lambda x, *d: x.permute(*d))(o, 0, 2, 1, 3).reshape(B, Sq, H * Dh) @ wo
```

```asm
; @launch grid=(256,1,1) block=(512,1,1) lds=143888
.amdgcn_target "amdgcn-amd-amdhsa--gfx950"
.text
.globl standalone__mha_block_cached__sampling_kernel
.p2align 8
.type standalone__mha_block_cached__sampling_kernel,@function
standalone__mha_block_cached__sampling_kernel:
    s_cmp_ge_u32 s2, 256
    s_cbranch_scc1 L_end
    s_load_dwordx16 s[4:19], s[0:1], 0
    v_lshrrev_b32 v1, 6, v0
    v_and_b32 v0, 63, v0
    s_and_b32 s50, s2, 7
    v_readfirstlane_b32 s20, v1
    s_lshr_b32 s23, s2, 3
    s_lshl_b32 s50, s50, 2
    s_and_b32 s51, s23, 3
    s_add_u32 s21, s50, s51
    s_lshr_b32 s22, s23, 2
    s_cmp_ge_u32 s20, 3
    s_cbranch_scc1 L_holder
    s_cmp_ge_u32 s20, 1
    s_cbranch_scc1 L_consumer
    s_setprio 3
    s_lshl_b32 s50, s22, 5
    s_add_u32 s50, s50, s21
    s_mul_i32 s50, s50, 1572864
    v_bfe_u32 v1, v0, 3, 2
    v_lshrrev_b32 v3, 5, v0
    v_mul_u32_u24 v2, 384, v1
    v_and_b32 v8, 7, v0
    v_lshl_add_u32 v2, v8, 4, v2
    v_mul_u32_u24 v8, 66048, v3
    v_add_u32 v8, v2, v8
    v_mov_b32 v6, v8
    v_add_u32 v5, 896, v8
    v_add_u32 v4, 1792, v8
    s_mul_i32 s62, s22, 4
    s_add_u32 s62, s62, 9
    s_mov_b32 s54, 122880
    s_mov_b32 s59, 0
    s_mul_i32 s55, s62, 1536
    s_mov_b32 s60, 0
    s_sub_u32 s57, 42, s62
    s_mov_b32 s58, 10
    s_waitcnt lgkmcnt(0)
    s_sub_u32 s6, s6, 1792
    s_subb_u32 s7, s7, 0
    s_add_u32 s24, s6, s50
    s_addc_u32 s25, s7, 0
    s_mov_b32 s26, 1574656
    s_mov_b32 s27, 0x20000
    s_add_u32 s54, s54, 12288
    s_cmp_eq_u32 s54, 135168
    s_cselect_b32 s54, 0, s54
    s_mov_b32 m0, s54
    s_nop 0
    buffer_load_dwordx4 v4, s[24:27], s55 offen offset:0 nt lds
    buffer_load_dwordx4 v5, s[24:27], s55 offen offset:1024 nt lds
    buffer_load_dwordx4 v6, s[24:27], s55 offen offset:2048 nt lds
    s_add_u32 s55, s55, 1536
    s_sub_u32 s57, s57, 1
    s_add_u32 m0, s54, 3072
    s_nop 0
    buffer_load_dwordx4 v4, s[24:27], s55 offen offset:0 nt lds
    buffer_load_dwordx4 v5, s[24:27], s55 offen offset:1024 nt lds
    buffer_load_dwordx4 v6, s[24:27], s55 offen offset:2048 nt lds
    s_add_u32 s55, s55, 1536
    s_sub_u32 s57, s57, 1
    s_add_u32 m0, s54, 6144
    s_nop 0
    buffer_load_dwordx4 v4, s[24:27], s55 offen offset:0 nt lds
    buffer_load_dwordx4 v5, s[24:27], s55 offen offset:1024 nt lds
    buffer_load_dwordx4 v6, s[24:27], s55 offen offset:2048 nt lds
    s_add_u32 s55, s55, 1536
    s_sub_u32 s57, s57, 1
    s_add_u32 m0, s54, 9216
    s_nop 0
    buffer_load_dwordx4 v4, s[24:27], s55 offen offset:0 nt lds
    buffer_load_dwordx4 v5, s[24:27], s55 offen offset:1024 nt lds
    buffer_load_dwordx4 v6, s[24:27], s55 offen offset:2048 nt lds
    s_add_u32 s55, s55, 1536
    s_sub_u32 s57, s57, 1
    s_sub_u32 s58, s58, 1
    s_sub_u32 s8, s8, 1792
    s_subb_u32 s9, s9, 0
    s_add_u32 s48, s8, s50
    s_addc_u32 s49, s9, 0
    v_mul_u32_u24 v10, 66048, v3
    v_add_u32 v10, 66048, v10
    v_add_u32 v10, v2, v10
    v_mul_u32_u24 v12, 64512, v3
    v_add_u32 v12, 132096, v12
    v_add_u32 v12, v2, v12
    v_mov_b32 v16, 143872
    v_mov_b32 v17, 18
    s_cmp_ge_u32 s22, 6
    s_cselect_b32 s47, 0, 1
    s_branch L_ld
L_ld_fill:
    s_cmp_lg_u32 s58, s47
    s_cbranch_scc1 L_ld_w18
    s_barrier
    s_branch L_ld_w18
L_ld:
    s_sub_u32 s58, s58, 1
    s_cbranch_scc0 L_ld_fill
    s_mov_b32 s58, 0
    s_waitcnt lgkmcnt(0)
    v_readfirstlane_b32 s61, v17
    s_barrier
    ds_read_b32 v17, v16
    s_cmp_eq_u32 s61, 17
    s_cbranch_scc1 L_ld_w17
    s_cmp_eq_u32 s61, 19
    s_cbranch_scc1 L_ld_w19
    s_cmp_eq_u32 s61, 16
    s_cbranch_scc1 L_ld_w16
    s_cmp_eq_u32 s61, 20
    s_cbranch_scc1 L_ld_w20
L_ld_w18:
    s_add_u32 s54, s54, 12288
    s_cmp_eq_u32 s54, 135168
    s_cselect_b32 s54, 0, s54
    s_mov_b32 m0, s54
    s_waitcnt vmcnt(18)
    buffer_load_dwordx4 v4, s[24:27], s55 offen offset:0 nt lds
    buffer_load_dwordx4 v5, s[24:27], s55 offen offset:1024 nt lds
    buffer_load_dwordx4 v6, s[24:27], s55 offen offset:2048 nt lds
    s_add_u32 s55, s55, 1536
    s_sub_u32 s57, s57, 1
    s_cbranch_scc1 L_ld_seg_18_0
L_ld_cont_18_0:
    s_add_u32 m0, s54, 3072
    s_waitcnt vmcnt(18)
    buffer_load_dwordx4 v4, s[24:27], s55 offen offset:0 nt lds
    buffer_load_dwordx4 v5, s[24:27], s55 offen offset:1024 nt lds
    buffer_load_dwordx4 v6, s[24:27], s55 offen offset:2048 nt lds
    s_add_u32 s55, s55, 1536
    s_sub_u32 s57, s57, 1
    s_cbranch_scc1 L_ld_seg_18_1
L_ld_cont_18_1:
    s_add_u32 m0, s54, 6144
    s_waitcnt vmcnt(18)
    buffer_load_dwordx4 v4, s[24:27], s55 offen offset:0 nt lds
    buffer_load_dwordx4 v5, s[24:27], s55 offen offset:1024 nt lds
    buffer_load_dwordx4 v6, s[24:27], s55 offen offset:2048 nt lds
    s_add_u32 s55, s55, 1536
    s_sub_u32 s57, s57, 1
    s_cbranch_scc1 L_ld_seg_18_2
L_ld_cont_18_2:
    s_add_u32 m0, s54, 9216
    s_waitcnt vmcnt(18)
    buffer_load_dwordx4 v4, s[24:27], s55 offen offset:0 nt lds
    buffer_load_dwordx4 v5, s[24:27], s55 offen offset:1024 nt lds
    buffer_load_dwordx4 v6, s[24:27], s55 offen offset:2048 nt lds
    s_add_u32 s55, s55, 1536
    s_sub_u32 s57, s57, 1
    s_cbranch_scc1 L_ld_seg_18_3
L_ld_cont_18_3:
    s_branch L_ld
L_ld_w17:
    s_add_u32 s54, s54, 12288
    s_cmp_eq_u32 s54, 135168
    s_cselect_b32 s54, 0, s54
    s_mov_b32 m0, s54
    s_waitcnt vmcnt(17)
    buffer_load_dwordx4 v4, s[24:27], s55 offen offset:0 nt lds
    buffer_load_dwordx4 v5, s[24:27], s55 offen offset:1024 nt lds
    buffer_load_dwordx4 v6, s[24:27], s55 offen offset:2048 nt lds
    s_add_u32 s55, s55, 1536
    s_sub_u32 s57, s57, 1
    s_cbranch_scc1 L_ld_seg_17_0
L_ld_cont_17_0:
    s_add_u32 m0, s54, 3072
    s_waitcnt vmcnt(17)
    buffer_load_dwordx4 v4, s[24:27], s55 offen offset:0 nt lds
    buffer_load_dwordx4 v5, s[24:27], s55 offen offset:1024 nt lds
    buffer_load_dwordx4 v6, s[24:27], s55 offen offset:2048 nt lds
    s_add_u32 s55, s55, 1536
    s_sub_u32 s57, s57, 1
    s_cbranch_scc1 L_ld_seg_17_1
L_ld_cont_17_1:
    s_add_u32 m0, s54, 6144
    s_waitcnt vmcnt(17)
    buffer_load_dwordx4 v4, s[24:27], s55 offen offset:0 nt lds
    buffer_load_dwordx4 v5, s[24:27], s55 offen offset:1024 nt lds
    buffer_load_dwordx4 v6, s[24:27], s55 offen offset:2048 nt lds
    s_add_u32 s55, s55, 1536
    s_sub_u32 s57, s57, 1
    s_cbranch_scc1 L_ld_seg_17_2
L_ld_cont_17_2:
    s_add_u32 m0, s54, 9216
    s_waitcnt vmcnt(17)
    buffer_load_dwordx4 v4, s[24:27], s55 offen offset:0 nt lds
    buffer_load_dwordx4 v5, s[24:27], s55 offen offset:1024 nt lds
    buffer_load_dwordx4 v6, s[24:27], s55 offen offset:2048 nt lds
    s_add_u32 s55, s55, 1536
    s_sub_u32 s57, s57, 1
    s_cbranch_scc1 L_ld_seg_17_3
L_ld_cont_17_3:
    s_branch L_ld
L_ld_w19:
    s_add_u32 s54, s54, 12288
    s_cmp_eq_u32 s54, 135168
    s_cselect_b32 s54, 0, s54
    s_mov_b32 m0, s54
    s_waitcnt vmcnt(19)
    buffer_load_dwordx4 v4, s[24:27], s55 offen offset:0 nt lds
    buffer_load_dwordx4 v5, s[24:27], s55 offen offset:1024 nt lds
    buffer_load_dwordx4 v6, s[24:27], s55 offen offset:2048 nt lds
    s_add_u32 s55, s55, 1536
    s_sub_u32 s57, s57, 1
    s_cbranch_scc1 L_ld_seg_19_0
L_ld_cont_19_0:
    s_add_u32 m0, s54, 3072
    s_waitcnt vmcnt(19)
    buffer_load_dwordx4 v4, s[24:27], s55 offen offset:0 nt lds
    buffer_load_dwordx4 v5, s[24:27], s55 offen offset:1024 nt lds
    buffer_load_dwordx4 v6, s[24:27], s55 offen offset:2048 nt lds
    s_add_u32 s55, s55, 1536
    s_sub_u32 s57, s57, 1
    s_cbranch_scc1 L_ld_seg_19_1
L_ld_cont_19_1:
    s_add_u32 m0, s54, 6144
    s_waitcnt vmcnt(19)
    buffer_load_dwordx4 v4, s[24:27], s55 offen offset:0 nt lds
    buffer_load_dwordx4 v5, s[24:27], s55 offen offset:1024 nt lds
    buffer_load_dwordx4 v6, s[24:27], s55 offen offset:2048 nt lds
    s_add_u32 s55, s55, 1536
    s_sub_u32 s57, s57, 1
    s_cbranch_scc1 L_ld_seg_19_2
L_ld_cont_19_2:
    s_add_u32 m0, s54, 9216
    s_waitcnt vmcnt(19)
    buffer_load_dwordx4 v4, s[24:27], s55 offen offset:0 nt lds
    buffer_load_dwordx4 v5, s[24:27], s55 offen offset:1024 nt lds
    buffer_load_dwordx4 v6, s[24:27], s55 offen offset:2048 nt lds
    s_add_u32 s55, s55, 1536
    s_sub_u32 s57, s57, 1
    s_cbranch_scc1 L_ld_seg_19_3
L_ld_cont_19_3:
    s_branch L_ld
L_ld_w16:
    s_add_u32 s54, s54, 12288
    s_cmp_eq_u32 s54, 135168
    s_cselect_b32 s54, 0, s54
    s_mov_b32 m0, s54
    s_waitcnt vmcnt(16)
    buffer_load_dwordx4 v4, s[24:27], s55 offen offset:0 nt lds
    buffer_load_dwordx4 v5, s[24:27], s55 offen offset:1024 nt lds
    buffer_load_dwordx4 v6, s[24:27], s55 offen offset:2048 nt lds
    s_add_u32 s55, s55, 1536
    s_sub_u32 s57, s57, 1
    s_cbranch_scc1 L_ld_seg_16_0
L_ld_cont_16_0:
    s_add_u32 m0, s54, 3072
    s_waitcnt vmcnt(16)
    buffer_load_dwordx4 v4, s[24:27], s55 offen offset:0 nt lds
    buffer_load_dwordx4 v5, s[24:27], s55 offen offset:1024 nt lds
    buffer_load_dwordx4 v6, s[24:27], s55 offen offset:2048 nt lds
    s_add_u32 s55, s55, 1536
    s_sub_u32 s57, s57, 1
    s_cbranch_scc1 L_ld_seg_16_1
L_ld_cont_16_1:
    s_add_u32 m0, s54, 6144
    s_waitcnt vmcnt(16)
    buffer_load_dwordx4 v4, s[24:27], s55 offen offset:0 nt lds
    buffer_load_dwordx4 v5, s[24:27], s55 offen offset:1024 nt lds
    buffer_load_dwordx4 v6, s[24:27], s55 offen offset:2048 nt lds
    s_add_u32 s55, s55, 1536
    s_sub_u32 s57, s57, 1
    s_cbranch_scc1 L_ld_seg_16_2
L_ld_cont_16_2:
    s_add_u32 m0, s54, 9216
    s_waitcnt vmcnt(16)
    buffer_load_dwordx4 v4, s[24:27], s55 offen offset:0 nt lds
    buffer_load_dwordx4 v5, s[24:27], s55 offen offset:1024 nt lds
    buffer_load_dwordx4 v6, s[24:27], s55 offen offset:2048 nt lds
    s_add_u32 s55, s55, 1536
    s_sub_u32 s57, s57, 1
    s_cbranch_scc1 L_ld_seg_16_3
L_ld_cont_16_3:
    s_branch L_ld
L_ld_w20:
    s_add_u32 s54, s54, 12288
    s_cmp_eq_u32 s54, 135168
    s_cselect_b32 s54, 0, s54
    s_mov_b32 m0, s54
    s_waitcnt vmcnt(20)
    buffer_load_dwordx4 v4, s[24:27], s55 offen offset:0 nt lds
    buffer_load_dwordx4 v5, s[24:27], s55 offen offset:1024 nt lds
    buffer_load_dwordx4 v6, s[24:27], s55 offen offset:2048 nt lds
    s_add_u32 s55, s55, 1536
    s_sub_u32 s57, s57, 1
    s_cbranch_scc1 L_ld_seg_20_0
L_ld_cont_20_0:
    s_add_u32 m0, s54, 3072
    s_waitcnt vmcnt(20)
    buffer_load_dwordx4 v4, s[24:27], s55 offen offset:0 nt lds
    buffer_load_dwordx4 v5, s[24:27], s55 offen offset:1024 nt lds
    buffer_load_dwordx4 v6, s[24:27], s55 offen offset:2048 nt lds
    s_add_u32 s55, s55, 1536
    s_sub_u32 s57, s57, 1
    s_cbranch_scc1 L_ld_seg_20_1
L_ld_cont_20_1:
    s_add_u32 m0, s54, 6144
    s_waitcnt vmcnt(20)
    buffer_load_dwordx4 v4, s[24:27], s55 offen offset:0 nt lds
    buffer_load_dwordx4 v5, s[24:27], s55 offen offset:1024 nt lds
    buffer_load_dwordx4 v6, s[24:27], s55 offen offset:2048 nt lds
    s_add_u32 s55, s55, 1536
    s_sub_u32 s57, s57, 1
    s_cbranch_scc1 L_ld_seg_20_2
L_ld_cont_20_2:
    s_add_u32 m0, s54, 9216
    s_waitcnt vmcnt(20)
    buffer_load_dwordx4 v4, s[24:27], s55 offen offset:0 nt lds
    buffer_load_dwordx4 v5, s[24:27], s55 offen offset:1024 nt lds
    buffer_load_dwordx4 v6, s[24:27], s55 offen offset:2048 nt lds
    s_add_u32 s55, s55, 1536
    s_sub_u32 s57, s57, 1
    s_cbranch_scc1 L_ld_seg_20_3
L_ld_cont_20_3:
    s_branch L_ld
L_ld_seg_18_0:
    s_call_b64 s[44:45], L_ld_seg
    s_branch L_ld_cont_18_0
L_ld_seg_18_1:
    s_call_b64 s[44:45], L_ld_seg
    s_branch L_ld_cont_18_1
L_ld_seg_18_2:
    s_call_b64 s[44:45], L_ld_seg
    s_branch L_ld_cont_18_2
L_ld_seg_18_3:
    s_call_b64 s[44:45], L_ld_seg
    s_branch L_ld_cont_18_3
L_ld_seg_17_0:
    s_call_b64 s[44:45], L_ld_seg
    s_branch L_ld_cont_17_0
L_ld_seg_17_1:
    s_call_b64 s[44:45], L_ld_seg
    s_branch L_ld_cont_17_1
L_ld_seg_17_2:
    s_call_b64 s[44:45], L_ld_seg
    s_branch L_ld_cont_17_2
L_ld_seg_17_3:
    s_call_b64 s[44:45], L_ld_seg
    s_branch L_ld_cont_17_3
L_ld_seg_19_0:
    s_call_b64 s[44:45], L_ld_seg
    s_branch L_ld_cont_19_0
L_ld_seg_19_1:
    s_call_b64 s[44:45], L_ld_seg
    s_branch L_ld_cont_19_1
L_ld_seg_19_2:
    s_call_b64 s[44:45], L_ld_seg
    s_branch L_ld_cont_19_2
L_ld_seg_19_3:
    s_call_b64 s[44:45], L_ld_seg
    s_branch L_ld_cont_19_3
L_ld_seg_16_0:
    s_call_b64 s[44:45], L_ld_seg
    s_branch L_ld_cont_16_0
L_ld_seg_16_1:
    s_call_b64 s[44:45], L_ld_seg
    s_branch L_ld_cont_16_1
L_ld_seg_16_2:
    s_call_b64 s[44:45], L_ld_seg
    s_branch L_ld_cont_16_2
L_ld_seg_16_3:
    s_call_b64 s[44:45], L_ld_seg
    s_branch L_ld_cont_16_3
L_ld_seg_20_0:
    s_call_b64 s[44:45], L_ld_seg
    s_branch L_ld_cont_20_0
L_ld_seg_20_1:
    s_call_b64 s[44:45], L_ld_seg
    s_branch L_ld_cont_20_1
L_ld_seg_20_2:
    s_call_b64 s[44:45], L_ld_seg
    s_branch L_ld_cont_20_2
L_ld_seg_20_3:
    s_call_b64 s[44:45], L_ld_seg
    s_branch L_ld_cont_20_3
L_ld_seg:
    s_add_u32 s59, s59, 1
    s_add_u32 s60, s60, 1
    s_cmp_eq_u32 s59, 13
    s_cbranch_scc1 L_ld_tov
    s_cmp_eq_u32 s59, 26
    s_cbranch_scc1 L_ld_done
    s_cmp_lg_u32 s60, 1
    s_cbranch_scc1 L_ld_not1
    v_mov_b32 v6, v10
    v_add_u32 v5, 896, v10
    v_add_u32 v4, 1792, v10
    s_mov_b32 s57, 42
    s_setpc_b64 s[44:45]
L_ld_not1:
    s_cmp_lg_u32 s60, 2
    s_cbranch_scc1 L_ld_not2
    v_mov_b32 v6, v12
    v_add_u32 v5, 896, v12
    v_add_u32 v4, 1792, v12
    s_mov_b32 s57, 41
    s_setpc_b64 s[44:45]
L_ld_not2:
    v_mov_b32 v6, v8
    v_add_u32 v5, 896, v8
    v_add_u32 v4, 1792, v8
    s_mov_b32 s60, 0
    s_add_u32 s55, s55, 196608
    s_mov_b32 s57, 42
    s_cmp_lt_u32 s55, 1572864
    s_cbranch_scc1 L_ld_ret
    s_cmp_eq_u32 s59, 12
    s_cselect_b32 s50, 0, 8
    s_sub_u32 s62, s62, s50
    s_mov_b32 s55, 0
    s_sub_u32 s57, s62, 1
L_ld_ret:
    s_setpc_b64 s[44:45]
L_ld_tov:
    s_mov_b32 s24, s48
    s_mov_b32 s25, s49
    s_mul_i32 s55, s62, 1536
    s_mov_b32 s60, 0
    s_sub_u32 s57, 42, s62
    s_setpc_b64 s[44:45]
L_ld_done:
    s_mul_i32 s55, s62, 1536
    s_waitcnt vmcnt(24)
    s_barrier
    s_add_u32 s50, s55, 0
    s_mov_b32 m0, 12288
    s_waitcnt vmcnt(21)
    buffer_load_dwordx4 v4, s[24:27], s50 offen offset:0 nt lds
    s_add_u32 s50, s55, 1536
    s_mov_b32 m0, 15360
    s_waitcnt vmcnt(21)
    buffer_load_dwordx4 v4, s[24:27], s50 offen offset:0 nt lds
    s_add_u32 s50, s55, 3072
    s_mov_b32 m0, 18432
    s_waitcnt vmcnt(21)
    buffer_load_dwordx4 v4, s[24:27], s50 offen offset:0 nt lds
    s_add_u32 s50, s55, 4608
    s_mov_b32 m0, 21504
    s_waitcnt vmcnt(21)
    buffer_load_dwordx4 v4, s[24:27], s50 offen offset:0 nt lds
    s_add_u32 s50, s55, 6144
    s_mov_b32 m0, 24576
    s_waitcnt vmcnt(21)
    buffer_load_dwordx4 v4, s[24:27], s50 offen offset:0 nt lds
    s_add_u32 s50, s55, 7680
    s_mov_b32 m0, 27648
    s_waitcnt vmcnt(21)
    buffer_load_dwordx4 v4, s[24:27], s50 offen offset:0 nt lds
    s_add_u32 s50, s55, 9216
    s_mov_b32 m0, 30720
    s_waitcnt vmcnt(21)
    buffer_load_dwordx4 v4, s[24:27], s50 offen offset:0 nt lds
    s_waitcnt vmcnt(19)
    s_barrier
    s_add_u32 s50, s55, 10752
    s_mov_b32 m0, 33792
    s_waitcnt vmcnt(21)
    buffer_load_dwordx4 v4, s[24:27], s50 offen offset:0 nt lds
    s_add_u32 s50, s55, 0
    s_mov_b32 m0, 12288
    s_waitcnt vmcnt(21)
    buffer_load_dwordx4 v5, s[24:27], s50 offen offset:1024 nt lds
    s_add_u32 s50, s55, 1536
    s_mov_b32 m0, 15360
    s_waitcnt vmcnt(21)
    buffer_load_dwordx4 v5, s[24:27], s50 offen offset:1024 nt lds
    s_add_u32 s50, s55, 3072
    s_mov_b32 m0, 18432
    s_waitcnt vmcnt(21)
    buffer_load_dwordx4 v5, s[24:27], s50 offen offset:1024 nt lds
    s_add_u32 s50, s55, 4608
    s_mov_b32 m0, 21504
    s_waitcnt vmcnt(21)
    buffer_load_dwordx4 v5, s[24:27], s50 offen offset:1024 nt lds
    s_add_u32 s50, s55, 6144
    s_mov_b32 m0, 24576
    s_waitcnt vmcnt(21)
    buffer_load_dwordx4 v5, s[24:27], s50 offen offset:1024 nt lds
    s_add_u32 s50, s55, 7680
    s_mov_b32 m0, 27648
    s_waitcnt vmcnt(21)
    buffer_load_dwordx4 v5, s[24:27], s50 offen offset:1024 nt lds
    s_add_u32 s50, s55, 9216
    s_mov_b32 m0, 30720
    s_waitcnt vmcnt(21)
    buffer_load_dwordx4 v5, s[24:27], s50 offen offset:1024 nt lds
    s_add_u32 s50, s55, 10752
    s_mov_b32 m0, 33792
    s_waitcnt vmcnt(21)
    buffer_load_dwordx4 v5, s[24:27], s50 offen offset:1024 nt lds
    s_add_u32 s50, s55, 0
    s_mov_b32 m0, 12288
    s_waitcnt vmcnt(21)
    buffer_load_dwordx4 v6, s[24:27], s50 offen offset:2048 nt lds
    s_add_u32 s50, s55, 1536
    s_mov_b32 m0, 15360
    s_waitcnt vmcnt(21)
    buffer_load_dwordx4 v6, s[24:27], s50 offen offset:2048 nt lds
    s_add_u32 s50, s55, 3072
    s_mov_b32 m0, 18432
    s_waitcnt vmcnt(21)
    buffer_load_dwordx4 v6, s[24:27], s50 offen offset:2048 nt lds
    s_waitcnt vmcnt(19)
    s_barrier
    s_add_u32 s50, s55, 4608
    s_mov_b32 m0, 21504
    s_waitcnt vmcnt(21)
    buffer_load_dwordx4 v6, s[24:27], s50 offen offset:2048 nt lds
    s_add_u32 s50, s55, 6144
    s_mov_b32 m0, 24576
    s_waitcnt vmcnt(21)
    buffer_load_dwordx4 v6, s[24:27], s50 offen offset:2048 nt lds
    s_add_u32 s50, s55, 7680
    s_mov_b32 m0, 27648
    s_waitcnt vmcnt(21)
    buffer_load_dwordx4 v6, s[24:27], s50 offen offset:2048 nt lds
    s_add_u32 s50, s55, 9216
    s_mov_b32 m0, 30720
    s_waitcnt vmcnt(21)
    buffer_load_dwordx4 v6, s[24:27], s50 offen offset:2048 nt lds
    s_add_u32 s50, s55, 10752
    s_mov_b32 m0, 33792
    s_waitcnt vmcnt(21)
    buffer_load_dwordx4 v6, s[24:27], s50 offen offset:2048 nt lds
    s_waitcnt vmcnt(16)
    s_barrier
    s_waitcnt vmcnt(8)
    s_barrier
    s_waitcnt vmcnt(0)
    s_barrier
    s_endpgm
L_consumer:
    s_sub_u32 s54, s20, 1
    v_lshlrev_b32 v4, 4, v0
    v_and_b32 v20, 1, v0
    v_lshlrev_b32 v20, 4, v20
    v_mov_b32 v21, 0xffff
    v_lshlrev_b32 v20, v20, v21
    v_bfe_u32 v21, v0, 1, 2
    v_cmp_eq_u32 vcc, 0, v21
    s_nop 1
    v_cndmask_b32 v28, 0, v20, vcc
    v_cmp_eq_u32 vcc, 1, v21
    s_nop 1
    v_cndmask_b32 v29, 0, v20, vcc
    v_cmp_eq_u32 vcc, 2, v21
    s_nop 1
    v_cndmask_b32 v30, 0, v20, vcc
    v_cmp_eq_u32 vcc, 3, v21
    s_nop 1
    v_cndmask_b32 v31, 0, v20, vcc
    s_mul_i32 s55, s54, 6144
    v_add_u32 v122, 12288, v4
    v_lshrrev_b32 v20, 3, v0
    s_lshl_b32 s50, s54, 5
    s_add_u32 s50, s50, 135168
    v_lshl_add_u32 v7, v20, 2, s50
    s_lshl_b32 s50, s54, 6
    s_add_u32 s50, s50, 143744
    v_lshl_add_u32 v120, v20, 3, s50
    v_mov_b32 v8, 0xff800000
    v_mov_b32 v9, 0
    v_mov_b32 v44, 0
    v_mov_b32 v45, 0
    v_mov_b32 v46, 0
    v_mov_b32 v47, 0
    v_mov_b32 v48, 0
    v_mov_b32 v49, 0
    v_mov_b32 v50, 0
    v_mov_b32 v51, 0
    v_mov_b32 v52, 0
    v_mov_b32 v53, 0
    v_mov_b32 v54, 0
    v_mov_b32 v55, 0
    v_and_b32 v121, 7, v0
    v_bfe_u32 v20, v0, 4, 1
    v_lshl_add_u32 v121, v121, 1, v20
    v_lshrrev_b32 v20, 5, v0
    v_lshl_add_u32 v121, v121, 1, v20
    v_lshlrev_b32 v121, 2, v121
    v_add_u32 v121, 135168, v121
    s_mov_b32 s62, 0x01010101
    s_mov_b32 s63, 0x01010101
    s_mov_b32 s60, 0x3d93cd3a
    s_mov_b32 s3, 0x3fb8aa3b
    s_waitcnt lgkmcnt(0)
    s_lshl_b32 s61, s22, 8
    s_add_u32 s61, s61, 0xc0000
    s_load_dword s61, s[18:19], s61
    s_mul_i32 s50, s22, 81920
    s_add_u32 s40, s18, s50
    s_addc_u32 s41, s19, 0
    s_mov_b32 s42, 81920
    s_mov_b32 s43, 0x20000
    s_mul_i32 s50, s22, 1280
    s_add_u32 s44, s14, s50
    s_addc_u32 s45, s15, 0
    s_mov_b32 s46, 1280
    s_mov_b32 s47, 0x20000
    s_and_b32 s50, s2, 7
    s_lshl_b32 s50, s50, 12
    s_add_u32 s50, s50, 0x200000
    v_and_b32 v124, 31, v0
    v_lshl_add_u32 v124, v124, 2, s50
    s_lshl_b32 s51, s23, 2
    s_add_u32 s50, s50, s51
    v_mov_b32 v125, s50
    s_sub_u32 s50, s50, s51
    s_add_u32 s50, s50, 128
    v_writelane_b32 v124, s50, 32
    v_mov_b32 v128, 143872
    v_mov_b32 v127, 18
    v_mov_b32 v126, 0
    s_mov_b32 s65, 0
    s_cmp_eq_u32 s54, 1
    s_cselect_b32 s64, 9, 0x7fffffff
    s_cbranch_scc0 L_c_noinit
    s_mov_b64 exec, 1
    global_store_dword v125, v126, s[18:19]
    s_mov_b64 exec, -1
L_c_noinit:
    ds_write_b32 v128, v127
    s_waitcnt lgkmcnt(0)
    s_add_u32 s61, s61, 0x01010101
    s_barrier
    s_barrier
    v_and_b32 v20, 7, v0
    v_lshlrev_b32 v20, 4, v20
    v_add_u32 v20, 143360, v20
    ds_read_b128 v[32:35], v20 offset:0
    ds_read_b128 v[36:39], v20 offset:128
    ds_read_b128 v[40:43], v20 offset:256
    s_mov_b32 s58, 0
    s_mov_b32 s59, 1
    s_mov_b32 s57, 0
L_c_k:
    v_add_u32 v5, s55, v4
    ds_read_b128 v[88:91], v5 offset:0
    ds_read_b128 v[92:95], v5 offset:1024
    ds_read_b128 v[96:99], v5 offset:2048
    ds_read_b128 v[100:103], v5 offset:3072
    ds_read_b128 v[104:107], v5 offset:4096
    ds_read_b128 v[108:111], v5 offset:5120
    s_add_u32 s55, s55, 12288
    s_cmp_ge_u32 s55, 135168
    s_cselect_b32 s50, 135168, 0
    s_sub_u32 s55, s55, s50
    s_waitcnt lgkmcnt(5)
    v_dot2_f32_bf16 v12, v88, v32, 0
    v_dot2_f32_bf16 v12, v89, v33, v12
    v_dot2_f32_bf16 v12, v90, v34, v12
    v_dot2_f32_bf16 v12, v91, v35, v12
    s_waitcnt lgkmcnt(4)
    v_dot2_f32_bf16 v12, v92, v36, v12
    v_dot2_f32_bf16 v12, v93, v37, v12
    v_dot2_f32_bf16 v12, v94, v38, v12
    v_dot2_f32_bf16 v12, v95, v39, v12
    s_waitcnt lgkmcnt(3)
    v_dot2_f32_bf16 v12, v96, v40, v12
    v_dot2_f32_bf16 v12, v97, v41, v12
    v_dot2_f32_bf16 v12, v98, v42, v12
    v_dot2_f32_bf16 v12, v99, v43, v12
    s_waitcnt lgkmcnt(2)
    v_dot2_f32_bf16 v13, v100, v32, 0
    v_dot2_f32_bf16 v13, v101, v33, v13
    v_dot2_f32_bf16 v13, v102, v34, v13
    v_dot2_f32_bf16 v13, v103, v35, v13
    s_waitcnt lgkmcnt(1)
    v_dot2_f32_bf16 v13, v104, v36, v13
    v_dot2_f32_bf16 v13, v105, v37, v13
    v_dot2_f32_bf16 v13, v106, v38, v13
    v_dot2_f32_bf16 v13, v107, v39, v13
    s_waitcnt lgkmcnt(0)
    v_dot2_f32_bf16 v13, v108, v40, v13
    v_dot2_f32_bf16 v13, v109, v41, v13
    v_dot2_f32_bf16 v13, v110, v42, v13
    v_dot2_f32_bf16 v13, v111, v43, v13
    v_add_f32_dpp v12, v12, v12 quad_perm:[1,0,3,2] row_mask:0xf bank_mask:0xf
    s_nop 1
    v_add_f32_dpp v13, v13, v13 quad_perm:[1,0,3,2] row_mask:0xf bank_mask:0xf
    v_add_f32_dpp v12, v12, v12 quad_perm:[2,3,0,1] row_mask:0xf bank_mask:0xf
    s_nop 0
    v_add_f32_dpp v13, v13, v13 quad_perm:[2,3,0,1] row_mask:0xf bank_mask:0xf
    v_add_f32_dpp v12, v12, v12 row_half_mirror row_mask:0xf bank_mask:0xf
    s_nop 0
    v_add_f32_dpp v13, v13, v13 row_half_mirror row_mask:0xf bank_mask:0xf
    v_cvt_pk_bf16_f32 v20, v12, v13
    v_lshlrev_b32 v12, 16, v20
    v_and_b32 v13, 0xffff0000, v20
    v_mul_f32 v12, s60, v12
    v_mul_f32 v13, s60, v13
    v_cvt_pk_bf16_f32 v20, v12, v13
    s_mov_b64 exec, s[62:63]
    ds_write_b32 v7, v20
    s_mov_b64 exec, -1
    v_lshlrev_b32 v12, 16, v20
    v_and_b32 v13, 0xffff0000, v20
    v_mov_b32 v14, v8
    v_max3_f32 v8, v8, v12, v13
    v_sub_f32 v12, v12, v8
    v_sub_f32 v13, v13, v8
    v_sub_f32 v14, v14, v8
    v_mul_f32 v12, s3, v12
    v_mul_f32 v13, s3, v13
    v_mul_f32 v14, s3, v14
    v_exp_f32 v12, v12
    v_exp_f32 v13, v13
    v_exp_f32 v14, v14
    s_add_u32 s57, s57, 1
    v_add_u32 v7, 64, v7
    v_add_f32 v12, v12, v13
    v_fma_f32 v9, v9, v14, v12
    s_cmp_eq_u32 s57, 128
    s_cbranch_scc1 L_c_kdone
    s_sub_u32 s59, s59, 1
    s_cmp_lg_u32 s59, 0
    s_cbranch_scc1 L_c_k
    s_add_u32 s58, s58, 1
    s_cmp_lt_u32 s58, s64
    s_cbranch_scc1 L_c_noctlk
    s_waitcnt vmcnt(0)
    v_readlane_b32 s52, v126, 32
    s_lshl_b32 s53, s65, 5
    v_subrev_u32 v126, s65, v126
    v_add_u32 v127, 24, v126
    v_cmp_gt_u32 vcc, 48, v127
    s_mov_b32 s65, s58
    s_add_u32 s64, s58, 2
    v_cndmask_b32 v127, 0, v126, vcc
    v_mov_b32 v126, s65
    s_mov_b64 exec, 1
    global_store_dword v125, v126, s[18:19]
    s_mov_b64 exec, -1
    v_add_u32_dpp v127, v127, v127 quad_perm:[1,0,3,2] row_mask:0xf bank_mask:0xf
    s_nop 1
    v_add_u32_dpp v127, v127, v127 quad_perm:[2,3,0,1] row_mask:0xf bank_mask:0xf
    s_nop 1
    v_add_u32_dpp v127, v127, v127 row_half_mirror row_mask:0xf bank_mask:0xf
    s_nop 1
    v_add_u32_dpp v127, v127, v127 row_mirror row_mask:0xf bank_mask:0xf
    s_nop 1
    global_load_dword v126, v124, s[18:19] sc1
    v_readlane_b32 s50, v127, 0
    v_readlane_b32 s51, v127, 16
    s_nop 1
    s_add_i32 s50, s50, s51
    s_add_i32 s53, s53, s50
    s_lshl_b32 s51, s58, 5
    s_sub_i32 s53, s53, s51
    v_mov_b32 v127, s53
    ds_write_b32 v128, v127 offset:4
    s_add_u32 s51, s52, 0x200
    s_cmp_lt_u32 s51, 0x400
    s_cselect_b32 s52, s52, 0
    s_mul_i32 s52, s52, 10
    s_ashr_i32 s52, s52, 4
    s_add_i32 s50, s50, s52
    s_add_i32 s50, s50, 20
    s_mul_i32 s50, s50, 112
    s_add_i32 s50, s50, 2048
    s_ashr_i32 s50, s50, 12
    s_max_i32 s50, s50, -2
    s_min_i32 s50, s50, 2
    s_add_i32 s50, s50, 18
    v_mov_b32 v127, s50
    ds_write_b32 v128, v127
L_c_noctlk:
    s_cmp_lt_u32 s58, 15
    s_cselect_b32 s59, 2, 1
    s_and_b32 s50, s58, 1
    s_cselect_b32 s59, 1, s59
    s_barrier
    s_branch L_c_k
L_c_kdone:
    s_mov_b64 exec, s[62:63]
    ds_write_b64 v120, v[8:9]
    s_mov_b64 exec, -1
    s_add_u32 s58, s58, 1
    v_subrev_u32 v7, 8192, v7
    v_and_b32 v20, 15, v0
    v_lshlrev_b32 v20, 3, v20
    v_add_u32 v20, 143744, v20
    s_waitcnt lgkmcnt(0)
    s_barrier
    ds_read_b64 v[12:13], v20
    s_waitcnt lgkmcnt(0)
    v_max_f32_dpp v8, v12, v12 quad_perm:[1,0,3,2] row_mask:0xf bank_mask:0xf
    s_nop 1
    v_max_f32_dpp v8, v8, v8 quad_perm:[2,3,0,1] row_mask:0xf bank_mask:0xf
    s_nop 1
    v_max_f32_dpp v8, v8, v8 row_half_mirror row_mask:0xf bank_mask:0xf
    s_nop 1
    v_max_f32_dpp v8, v8, v8 row_mirror row_mask:0xf bank_mask:0xf
    s_nop 1
    v_sub_f32 v12, v12, v8
    v_mul_f32 v12, s3, v12
    v_exp_f32 v12, v12
    s_nop 0
    v_mul_f32 v9, v12, v13
    s_nop 1
    v_add_f32_dpp v9, v9, v9 quad_perm:[1,0,3,2] row_mask:0xf bank_mask:0xf
    s_nop 1
    v_add_f32_dpp v9, v9, v9 quad_perm:[2,3,0,1] row_mask:0xf bank_mask:0xf
    s_nop 1
    v_add_f32_dpp v9, v9, v9 row_half_mirror row_mask:0xf bank_mask:0xf
    s_nop 1
    v_add_f32_dpp v9, v9, v9 row_mirror row_mask:0xf bank_mask:0xf
    v_rcp_f32 v10, v9
    s_mov_b32 s57, 0
    v_fma_f32 v11, -v9, v10, 1.0
    v_fma_f32 v10, v11, v10, v10
L_c_v:
    ds_read_b32 v20, v7
    v_add_u32 v5, s55, v4
    ds_read_b128 v[88:91], v5 offset:0
    ds_read_b128 v[92:95], v5 offset:1024
    ds_read_b128 v[96:99], v5 offset:2048
    ds_read_b128 v[100:103], v5 offset:3072
    ds_read_b128 v[104:107], v5 offset:4096
    ds_read_b128 v[108:111], v5 offset:5120
    s_add_u32 s55, s55, 12288
    s_cmp_ge_u32 s55, 135168
    s_cselect_b32 s50, 135168, 0
    s_sub_u32 s55, s55, s50
    v_add_u32 v7, 64, v7
    s_waitcnt lgkmcnt(6)
    v_lshlrev_b32 v12, 16, v20
    v_and_b32 v13, 0xffff0000, v20
    v_sub_f32 v12, v12, v8
    v_sub_f32 v13, v13, v8
    v_mul_f32 v12, s3, v12
    v_mul_f32 v13, s3, v13
    v_exp_f32 v12, v12
    v_exp_f32 v13, v13
    s_add_u32 s57, s57, 1
    v_mul_f32 v12, v10, v12
    v_mul_f32 v13, v10, v13
    v_cvt_pk_bf16_f32 v12, v12, v12
    v_cvt_pk_bf16_f32 v13, v13, v13
    v_and_b32 v56, v28, v12
    v_and_b32 v57, v29, v12
    v_and_b32 v58, v30, v12
    v_and_b32 v59, v31, v12
    v_and_b32 v60, v28, v13
    v_and_b32 v61, v29, v13
    v_and_b32 v62, v30, v13
    v_and_b32 v63, v31, v13
    s_nop 0
    s_waitcnt lgkmcnt(5)
    v_mfma_f32_16x16x32_bf16 v[44:47], v[56:59], v[88:91], v[44:47]
    s_waitcnt lgkmcnt(4)
    v_mfma_f32_16x16x32_bf16 v[48:51], v[56:59], v[92:95], v[48:51]
    s_waitcnt lgkmcnt(3)
    v_mfma_f32_16x16x32_bf16 v[52:55], v[56:59], v[96:99], v[52:55]
    s_waitcnt lgkmcnt(2)
    v_mfma_f32_16x16x32_bf16 v[44:47], v[60:63], v[100:103], v[44:47]
    s_waitcnt lgkmcnt(1)
    v_mfma_f32_16x16x32_bf16 v[48:51], v[60:63], v[104:107], v[48:51]
    s_waitcnt lgkmcnt(0)
    v_mfma_f32_16x16x32_bf16 v[52:55], v[60:63], v[108:111], v[52:55]
    s_cmp_eq_u32 s57, 125
    s_cbranch_scc1 L_c_vdone
    s_add_u32 s58, s58, 1
    s_cmp_lt_u32 s58, s64
    s_cbranch_scc1 L_c_noctlv
    s_waitcnt vmcnt(0)
    v_readlane_b32 s52, v126, 32
    s_lshl_b32 s53, s65, 5
    v_subrev_u32 v126, s65, v126
    v_add_u32 v127, 24, v126
    v_cmp_gt_u32 vcc, 48, v127
    s_mov_b32 s65, s58
    s_add_u32 s64, s58, 2
    v_cndmask_b32 v127, 0, v126, vcc
    v_mov_b32 v126, s65
    s_mov_b64 exec, 1
    global_store_dword v125, v126, s[18:19]
    s_mov_b64 exec, -1
    v_add_u32_dpp v127, v127, v127 quad_perm:[1,0,3,2] row_mask:0xf bank_mask:0xf
    s_nop 1
    v_add_u32_dpp v127, v127, v127 quad_perm:[2,3,0,1] row_mask:0xf bank_mask:0xf
    s_nop 1
    v_add_u32_dpp v127, v127, v127 row_half_mirror row_mask:0xf bank_mask:0xf
    s_nop 1
    v_add_u32_dpp v127, v127, v127 row_mirror row_mask:0xf bank_mask:0xf
    s_nop 1
    global_load_dword v126, v124, s[18:19] sc1
    v_readlane_b32 s50, v127, 0
    v_readlane_b32 s51, v127, 16
    s_nop 1
    s_add_i32 s50, s50, s51
    s_add_i32 s53, s53, s50
    s_lshl_b32 s51, s58, 5
    s_sub_i32 s53, s53, s51
    v_mov_b32 v127, s53
    ds_write_b32 v128, v127 offset:4
    s_add_u32 s51, s52, 0x200
    s_cmp_lt_u32 s51, 0x400
    s_cselect_b32 s52, s52, 0
    s_mul_i32 s52, s52, 10
    s_ashr_i32 s52, s52, 4
    s_add_i32 s50, s50, s52
    s_add_i32 s50, s50, 20
    s_mul_i32 s50, s50, 112
    s_add_i32 s50, s50, 2048
    s_ashr_i32 s50, s50, 12
    s_max_i32 s50, s50, -2
    s_min_i32 s50, s50, 2
    s_add_i32 s50, s50, 18
    v_mov_b32 v127, s50
    ds_write_b32 v128, v127
L_c_noctlv:
    s_barrier
    s_branch L_c_v
L_c_vdone:
    s_lshl_b32 s50, s54, 5
    v_subrev_u32 v5, s50, v7
    ds_read_b32 v20, v5 offset:64
    ds_read_b32 v21, v5 offset:96
    ds_read_b32 v22, v5 offset:128
    ds_read_b32 v23, v5 offset:160
    s_waitcnt lgkmcnt(0)
    v_lshlrev_b32 v12, 16, v20
    v_and_b32 v13, 0xffff0000, v20
    v_lshlrev_b32 v14, 16, v21
    v_and_b32 v15, 0xffff0000, v21
    v_lshlrev_b32 v16, 16, v22
    v_and_b32 v17, 0xffff0000, v22
    v_lshlrev_b32 v18, 16, v23
    v_and_b32 v19, 0xffff0000, v23
    v_sub_f32 v12, v12, v8
    v_sub_f32 v13, v13, v8
    v_sub_f32 v14, v14, v8
    v_sub_f32 v15, v15, v8
    v_sub_f32 v16, v16, v8
    v_sub_f32 v17, v17, v8
    v_sub_f32 v18, v18, v8
    v_sub_f32 v19, v19, v8
    v_mul_f32 v12, s3, v12
    v_mul_f32 v13, s3, v13
    v_mul_f32 v14, s3, v14
    v_mul_f32 v15, s3, v15
    v_mul_f32 v16, s3, v16
    v_mul_f32 v17, s3, v17
    v_mul_f32 v18, s3, v18
    v_mul_f32 v19, s3, v19
    v_exp_f32 v12, v12
    v_exp_f32 v13, v13
    v_exp_f32 v14, v14
    v_exp_f32 v15, v15
    v_exp_f32 v16, v16
    v_exp_f32 v17, v17
    v_exp_f32 v18, v18
    v_exp_f32 v19, v19
    s_add_u32 s57, s57, 1
    v_mul_f32 v12, v10, v12
    v_mul_f32 v13, v10, v13
    v_mul_f32 v14, v10, v14
    v_mul_f32 v15, v10, v15
    v_mul_f32 v16, v10, v16
    v_mul_f32 v17, v10, v17
    v_mul_f32 v18, v10, v18
    v_mul_f32 v19, v10, v19
    v_cvt_pk_bf16_f32 v12, v12, v12
    v_cvt_pk_bf16_f32 v13, v13, v13
    v_cvt_pk_bf16_f32 v14, v14, v14
    v_cvt_pk_bf16_f32 v15, v15, v15
    v_cvt_pk_bf16_f32 v16, v16, v16
    v_cvt_pk_bf16_f32 v17, v17, v17
    v_cvt_pk_bf16_f32 v18, v18, v18
    v_cvt_pk_bf16_f32 v19, v19, v19
    v_and_b32 v164, v28, v12
    v_and_b32 v165, v29, v12
    v_and_b32 v166, v30, v12
    v_and_b32 v167, v31, v12
    v_and_b32 v168, v28, v13
    v_and_b32 v169, v29, v13
    v_and_b32 v170, v30, v13
    v_and_b32 v171, v31, v13
    v_and_b32 v172, v28, v14
    v_and_b32 v173, v29, v14
    v_and_b32 v174, v30, v14
    v_and_b32 v175, v31, v14
    v_and_b32 v176, v28, v15
    v_and_b32 v177, v29, v15
    v_and_b32 v178, v30, v15
    v_and_b32 v179, v31, v15
    v_and_b32 v180, v28, v16
    v_and_b32 v181, v29, v16
    v_and_b32 v182, v30, v16
    v_and_b32 v183, v31, v16
    v_and_b32 v184, v28, v17
    v_and_b32 v185, v29, v17
    v_and_b32 v186, v30, v17
    v_and_b32 v187, v31, v17
    v_and_b32 v188, v28, v18
    v_and_b32 v189, v29, v18
    v_and_b32 v190, v30, v18
    v_and_b32 v191, v31, v18
    v_and_b32 v192, v28, v19
    v_and_b32 v193, v29, v19
    v_and_b32 v194, v30, v19
    v_and_b32 v195, v31, v19
    s_barrier
    ds_read_b32 v20, v7
    v_add_u32 v5, s55, v4
    ds_read_b128 v[88:91], v5 offset:0
    ds_read_b128 v[92:95], v5 offset:1024
    ds_read_b128 v[96:99], v5 offset:2048
    ds_read_b128 v[100:103], v5 offset:3072
    ds_read_b128 v[104:107], v5 offset:4096
    ds_read_b128 v[108:111], v5 offset:5120
    s_add_u32 s55, s55, 12288
    s_cmp_ge_u32 s55, 135168
    s_cselect_b32 s50, 135168, 0
    s_sub_u32 s55, s55, s50
    v_add_u32 v7, 64, v7
    s_waitcnt lgkmcnt(6)
    v_lshlrev_b32 v12, 16, v20
    v_and_b32 v13, 0xffff0000, v20
    v_sub_f32 v12, v12, v8
    v_sub_f32 v13, v13, v8
    v_mul_f32 v12, s3, v12
    v_mul_f32 v13, s3, v13
    v_exp_f32 v12, v12
    v_exp_f32 v13, v13
    s_add_u32 s57, s57, 1
    v_mul_f32 v12, v10, v12
    v_mul_f32 v13, v10, v13
    v_cvt_pk_bf16_f32 v12, v12, v12
    v_cvt_pk_bf16_f32 v13, v13, v13
    v_and_b32 v56, v28, v12
    v_and_b32 v57, v29, v12
    v_and_b32 v58, v30, v12
    v_and_b32 v59, v31, v12
    v_and_b32 v60, v28, v13
    v_and_b32 v61, v29, v13
    v_and_b32 v62, v30, v13
    v_and_b32 v63, v31, v13
    s_nop 0
    s_waitcnt lgkmcnt(5)
    v_mfma_f32_16x16x32_bf16 v[44:47], v[56:59], v[88:91], v[44:47]
    s_waitcnt lgkmcnt(4)
    v_mfma_f32_16x16x32_bf16 v[48:51], v[56:59], v[92:95], v[48:51]
    s_waitcnt lgkmcnt(3)
    v_mfma_f32_16x16x32_bf16 v[52:55], v[56:59], v[96:99], v[52:55]
    s_waitcnt lgkmcnt(2)
    v_mfma_f32_16x16x32_bf16 v[44:47], v[60:63], v[100:103], v[44:47]
    s_waitcnt lgkmcnt(1)
    v_mfma_f32_16x16x32_bf16 v[48:51], v[60:63], v[104:107], v[48:51]
    s_waitcnt lgkmcnt(0)
    v_mfma_f32_16x16x32_bf16 v[52:55], v[60:63], v[108:111], v[52:55]
    v_add_u32 v5, 135680, v4
    s_nop 3
    s_cmp_lg_u32 s54, 0
    s_cbranch_scc1 L_c_give1
    ds_write_b128 v5, v[48:51] offset:1024
    s_branch L_c_given
L_c_give1:
    ds_write_b128 v5, v[44:47]
    ds_write_b128 v5, v[52:55] offset:2048
L_c_given:
    s_waitcnt lgkmcnt(0)
    s_cmp_lg_u32 s54, 0
    s_barrier
    s_cbranch_scc0 L_c_fin0
    ds_read_b128 v[32:35], v5 offset:1024
    s_waitcnt lgkmcnt(0)
    v_add_f32 v48, v48, v32
    v_add_f32 v49, v49, v33
    v_add_f32 v50, v50, v34
    v_add_f32 v51, v51, v35
    s_barrier
    ds_read_b128 v[88:91], v122 offset:1024
    ds_read_b128 v[92:95], v122 offset:4096
    ds_read_b128 v[96:99], v122 offset:7168
    ds_read_b128 v[100:103], v122 offset:10240
    ds_read_b128 v[104:107], v122 offset:13312
    ds_read_b128 v[108:111], v122 offset:16384
    ds_read_b128 v[112:115], v122 offset:19456
    ds_read_b128 v[116:119], v122 offset:22528
    s_waitcnt lgkmcnt(7)
    v_mfma_f32_16x16x32_bf16 v[48:51], v[164:167], v[88:91], v[48:51]
    s_waitcnt lgkmcnt(6)
    v_mfma_f32_16x16x32_bf16 v[48:51], v[168:171], v[92:95], v[48:51]
    s_waitcnt lgkmcnt(5)
    v_mfma_f32_16x16x32_bf16 v[48:51], v[172:175], v[96:99], v[48:51]
    s_waitcnt lgkmcnt(4)
    v_mfma_f32_16x16x32_bf16 v[48:51], v[176:179], v[100:103], v[48:51]
    s_waitcnt lgkmcnt(3)
    v_mfma_f32_16x16x32_bf16 v[48:51], v[180:183], v[104:107], v[48:51]
    s_waitcnt lgkmcnt(2)
    v_mfma_f32_16x16x32_bf16 v[48:51], v[184:187], v[108:111], v[48:51]
    s_waitcnt lgkmcnt(1)
    v_mfma_f32_16x16x32_bf16 v[48:51], v[188:191], v[112:115], v[48:51]
    s_waitcnt lgkmcnt(0)
    v_mfma_f32_16x16x32_bf16 v[48:51], v[192:195], v[116:119], v[48:51]
    s_nop 7
    v_permlane32_swap_b32 v48, v50
    v_permlane32_swap_b32 v49, v51
    s_nop 0
    v_add_f32_dpp v20, v50, v48 row_ror:8 row_mask:0xf bank_mask:0xf
    v_add_f32_dpp v21, v51, v49 row_ror:8 row_mask:0xf bank_mask:0xf
    s_mov_b32 exec_lo, 0x00ff00ff
    s_mov_b32 exec_hi, 0x00ff00ff
    v_cvt_pk_bf16_f32 v20, v20, v21
    ds_write_b32 v121, v20 offset:128
    s_mov_b64 exec, -1
    s_waitcnt lgkmcnt(0)
    s_barrier
    s_endpgm
L_c_fin0:
    ds_read_b128 v[32:35], v5 offset:0
    s_waitcnt lgkmcnt(0)
    v_add_f32 v44, v44, v32
    v_add_f32 v45, v45, v33
    v_add_f32 v46, v46, v34
    v_add_f32 v47, v47, v35
    ds_read_b128 v[88:91], v122 offset:0
    ds_read_b128 v[92:95], v122 offset:3072
    ds_read_b128 v[96:99], v122 offset:6144
    ds_read_b128 v[100:103], v122 offset:9216
    ds_read_b128 v[104:107], v122 offset:12288
    ds_read_b128 v[108:111], v122 offset:15360
    ds_read_b128 v[112:115], v122 offset:18432
    ds_read_b128 v[116:119], v122 offset:21504
    s_waitcnt lgkmcnt(7)
    v_mfma_f32_16x16x32_bf16 v[44:47], v[164:167], v[88:91], v[44:47]
    s_waitcnt lgkmcnt(6)
    v_mfma_f32_16x16x32_bf16 v[44:47], v[168:171], v[92:95], v[44:47]
    s_waitcnt lgkmcnt(5)
    v_mfma_f32_16x16x32_bf16 v[44:47], v[172:175], v[96:99], v[44:47]
    s_waitcnt lgkmcnt(4)
    v_mfma_f32_16x16x32_bf16 v[44:47], v[176:179], v[100:103], v[44:47]
    s_waitcnt lgkmcnt(3)
    v_mfma_f32_16x16x32_bf16 v[44:47], v[180:183], v[104:107], v[44:47]
    s_waitcnt lgkmcnt(2)
    v_mfma_f32_16x16x32_bf16 v[44:47], v[184:187], v[108:111], v[44:47]
    s_waitcnt lgkmcnt(1)
    v_mfma_f32_16x16x32_bf16 v[44:47], v[188:191], v[112:115], v[44:47]
    s_waitcnt lgkmcnt(0)
    v_mfma_f32_16x16x32_bf16 v[44:47], v[192:195], v[116:119], v[44:47]
    s_nop 7
    v_permlane32_swap_b32 v44, v46
    v_permlane32_swap_b32 v45, v47
    s_nop 0
    v_add_f32_dpp v20, v46, v44 row_ror:8 row_mask:0xf bank_mask:0xf
    v_add_f32_dpp v21, v47, v45 row_ror:8 row_mask:0xf bank_mask:0xf
    s_mov_b32 exec_lo, 0x00ff00ff
    s_mov_b32 exec_hi, 0x00ff00ff
    v_cvt_pk_bf16_f32 v20, v20, v21
    ds_write_b32 v121, v20 offset:0
    s_mov_b64 exec, -1
    s_waitcnt lgkmcnt(0)
    s_barrier
    ds_read_b128 v[32:35], v5 offset:2048
    s_waitcnt lgkmcnt(0)
    v_add_f32 v52, v52, v32
    v_add_f32 v53, v53, v33
    v_add_f32 v54, v54, v34
    v_add_f32 v55, v55, v35
    s_mov_b32 s59, s21
    s_lshl_b32 s56, s59, 12
    s_mov_b32 s55, 0
    s_bfe_u32 s50, s61, 0x80000
    s_bfe_u32 s51, s61, 0x80008
    s_bfe_u32 s52, s61, 0x80010
    s_bfe_u32 s53, s61, 0x80018
    v_and_b32 v1, 7, v0
    v_bfe_u32 v2, v0, 4, 1
    v_lshrrev_b32 v3, 5, v0
    v_lshl_add_u32 v2, v2, 1, v3
    v_lshl_add_u32 v1, v1, 2, v2
    v_lshlrev_b32 v1, 1, v1
    s_barrier
    ds_read_b128 v[88:91], v122 offset:2048
    ds_read_b128 v[92:95], v122 offset:5120
    ds_read_b128 v[96:99], v122 offset:8192
    ds_read_b128 v[100:103], v122 offset:11264
    ds_read_b128 v[104:107], v122 offset:14336
    ds_read_b128 v[108:111], v122 offset:17408
    ds_read_b128 v[112:115], v122 offset:20480
    ds_read_b128 v[116:119], v122 offset:23552
    s_waitcnt lgkmcnt(7)
    v_mfma_f32_16x16x32_bf16 v[52:55], v[164:167], v[88:91], v[52:55]
    s_waitcnt lgkmcnt(6)
    v_mfma_f32_16x16x32_bf16 v[52:55], v[168:171], v[92:95], v[52:55]
    s_waitcnt lgkmcnt(5)
    v_mfma_f32_16x16x32_bf16 v[52:55], v[172:175], v[96:99], v[52:55]
    s_waitcnt lgkmcnt(4)
    v_mfma_f32_16x16x32_bf16 v[52:55], v[176:179], v[100:103], v[52:55]
    s_waitcnt lgkmcnt(3)
    v_mfma_f32_16x16x32_bf16 v[52:55], v[180:183], v[104:107], v[52:55]
    s_waitcnt lgkmcnt(2)
    v_mfma_f32_16x16x32_bf16 v[52:55], v[184:187], v[108:111], v[52:55]
    s_waitcnt lgkmcnt(1)
    v_mfma_f32_16x16x32_bf16 v[52:55], v[188:191], v[112:115], v[52:55]
    s_waitcnt lgkmcnt(0)
    v_mfma_f32_16x16x32_bf16 v[52:55], v[192:195], v[116:119], v[52:55]
    s_nop 7
    v_permlane32_swap_b32 v52, v54
    v_permlane32_swap_b32 v53, v55
    s_nop 0
    v_add_f32_dpp v20, v54, v52 row_ror:8 row_mask:0xf bank_mask:0xf
    v_add_f32_dpp v21, v55, v53 row_ror:8 row_mask:0xf bank_mask:0xf
    s_mov_b32 exec_lo, 0x00ff00ff
    s_mov_b32 exec_hi, 0x00ff00ff
    v_cvt_pk_bf16_f32 v20, v20, v21
    ds_write_b32 v121, v20 offset:256
    s_mov_b64 exec, -1
    s_waitcnt lgkmcnt(0)
    s_barrier
    s_cmp_ge_u32 s59, 20
    s_cbranch_scc1 L_r_done
    s_barrier
    buffer_load_dwordx4 v[132:135], v4, s[40:43], s56 offen offset:0 sc1
    buffer_load_dwordx4 v[136:139], v4, s[40:43], s56 offen offset:1024 sc1
    buffer_load_dwordx4 v[140:143], v4, s[40:43], s56 offen offset:2048 sc1
    buffer_load_dwordx4 v[144:147], v4, s[40:43], s56 offen offset:3072 sc1
L_r_poll:
    buffer_load_dwordx4 v[148:151], v4, s[40:43], s56 offen offset:0 sc1
    buffer_load_dwordx4 v[152:155], v4, s[40:43], s56 offen offset:1024 sc1
    buffer_load_dwordx4 v[156:159], v4, s[40:43], s56 offen offset:2048 sc1
    buffer_load_dwordx4 v[160:163], v4, s[40:43], s56 offen offset:3072 sc1
    s_waitcnt vmcnt(7)
    v_xor_b32 v88, s50, v132
    v_xor_b32 v89, s51, v133
    v_xor_b32 v90, s52, v134
    v_xor_b32 v91, s53, v135
    v_or3_b32 v2, v88, v89, v90
    v_or_b32 v2, v2, v91
    s_waitcnt vmcnt(6)
    v_xor_b32 v92, s50, v136
    v_xor_b32 v93, s51, v137
    v_xor_b32 v94, s52, v138
    v_xor_b32 v95, s53, v139
    v_or3_b32 v2, v2, v92, v93
    v_or3_b32 v2, v2, v94, v95
    s_waitcnt vmcnt(5)
    v_xor_b32 v96, s50, v140
    v_xor_b32 v97, s51, v141
    v_xor_b32 v98, s52, v142
    v_xor_b32 v99, s53, v143
    v_or3_b32 v2, v2, v96, v97
    v_or3_b32 v2, v2, v98, v99
    s_waitcnt vmcnt(4)
    v_xor_b32 v100, s50, v144
    v_xor_b32 v101, s51, v145
    v_xor_b32 v102, s52, v146
    v_xor_b32 v103, s53, v147
    v_or3_b32 v2, v2, v100, v101
    v_or3_b32 v2, v2, v102, v103
    v_and_b32 v2, 0xff, v2
    v_cmp_ne_u32 vcc, 0, v2
    s_cbranch_vccz L_r_sum
    s_bcnt1_i32_b64 s57, vcc
    s_cmp_le_u32 s57, 24
    s_cbranch_scc1 L_r_near0
    s_sleep 4
L_r_near0:
    buffer_load_dwordx4 v[132:135], v4, s[40:43], s56 offen offset:0 sc1
    buffer_load_dwordx4 v[136:139], v4, s[40:43], s56 offen offset:1024 sc1
    buffer_load_dwordx4 v[140:143], v4, s[40:43], s56 offen offset:2048 sc1
    buffer_load_dwordx4 v[144:147], v4, s[40:43], s56 offen offset:3072 sc1
    s_waitcnt vmcnt(7)
    v_xor_b32 v88, s50, v148
    v_xor_b32 v89, s51, v149
    v_xor_b32 v90, s52, v150
    v_xor_b32 v91, s53, v151
    v_or3_b32 v2, v88, v89, v90
    v_or_b32 v2, v2, v91
    s_waitcnt vmcnt(6)
    v_xor_b32 v92, s50, v152
    v_xor_b32 v93, s51, v153
    v_xor_b32 v94, s52, v154
    v_xor_b32 v95, s53, v155
    v_or3_b32 v2, v2, v92, v93
    v_or3_b32 v2, v2, v94, v95
    s_waitcnt vmcnt(5)
    v_xor_b32 v96, s50, v156
    v_xor_b32 v97, s51, v157
    v_xor_b32 v98, s52, v158
    v_xor_b32 v99, s53, v159
    v_or3_b32 v2, v2, v96, v97
    v_or3_b32 v2, v2, v98, v99
    s_waitcnt vmcnt(4)
    v_xor_b32 v100, s50, v160
    v_xor_b32 v101, s51, v161
    v_xor_b32 v102, s52, v162
    v_xor_b32 v103, s53, v163
    v_or3_b32 v2, v2, v100, v101
    v_or3_b32 v2, v2, v102, v103
    v_and_b32 v2, 0xff, v2
    v_cmp_ne_u32 vcc, 0, v2
    s_cbranch_vccz L_r_sum
    s_bcnt1_i32_b64 s57, vcc
    s_cmp_le_u32 s57, 24
    s_cbranch_scc1 L_r_near1
    s_sleep 4
L_r_near1:
    s_add_u32 s55, s55, 1
    s_cmp_lt_u32 s55, 0x100000
    s_cbranch_scc1 L_r_poll
L_r_sum:
    v_add_f32 v88, v88, v92
    v_add_f32 v96, v96, v100
    v_add_f32 v89, v89, v93
    v_add_f32 v97, v97, v101
    v_add_f32 v90, v90, v94
    v_add_f32 v98, v98, v102
    v_add_f32 v91, v91, v95
    v_add_f32 v99, v99, v103
    v_add_f32 v88, v88, v96
    v_add_f32 v89, v89, v97
    v_add_f32 v90, v90, v98
    v_add_f32 v91, v91, v99
    s_lshl_b32 s56, s59, 6
    s_nop 0
    v_permlane32_swap_b32 v88, v89
    v_permlane32_swap_b32 v90, v91
    s_nop 0
    v_add_f32 v88, v88, v89
    v_add_f32 v90, v90, v91
    s_nop 1
    v_permlane16_swap_b32 v88, v90
    s_nop 0
    v_add_f32 v88, v88, v90
    s_nop 1
    v_add_f32_dpp v88, v88, v88 row_ror:8 row_mask:0xf bank_mask:0xf
    s_mov_b32 exec_lo, 0x00ff00ff
    s_mov_b32 exec_hi, 0x00ff00ff
    v_cvt_pk_bf16_f32 v88, v88, v88
    buffer_store_short v88, v1, s[44:47], s56 offen
    s_cmp_lg_u32 s21, 0
    s_cbranch_scc1 L_r_done
    s_lshl_b32 s50, s22, 8
    s_add_u32 s50, s50, 0xc0000
    s_mov_b64 exec, 1
    v_mov_b32 v1, s50
    v_mov_b32 v2, s61
    global_store_dword v1, v2, s[18:19] sc1
L_r_done:
    s_endpgm
L_holder:
    s_sub_u32 s54, s20, 3
    s_mov_b32 s60, 0x05040100
    s_mov_b32 s61, 0x07060302
    s_cmp_lg_u32 s54, 0
    s_cbranch_scc1 L_h_setup
    v_and_b32 v1, 7, v0
    v_bfe_u32 v2, v0, 3, 1
    v_lshrrev_b32 v3, 4, v0
    v_lshl_add_u32 v29, v2, 2, v3
    v_mul_u32_u24 v4, 98304, v29
    v_lshl_add_u32 v4, v1, 4, v4
    v_mul_u32_u24 v30, 1280, v1
    v_lshl_add_u32 v30, v29, 4, v30
    v_lshlrev_b32 v31, 11, v1
    s_cmp_ge_u32 s22, 3
    s_cselect_b32 s52, 320, 0
    s_cselect_b32 s53, 3, 0
    s_sub_u32 s53, s22, s53
    s_mul_i32 s55, s52, 12288
    s_lshl_b32 s53, s53, 7
    s_add_u32 s55, s55, s53
    s_lshl_b32 s52, s52, 1
    s_mul_i32 s50, s21, 384
    s_lshl_b32 s51, s21, 14
    s_add_u32 s51, s51, 0x100000
    s_waitcnt lgkmcnt(0)
    s_add_u32 s40, s18, s51
    s_addc_u32 s41, s19, 0
    s_mov_b32 s42, 16384
    s_mov_b32 s43, 0x20000
    s_lshl_b32 s57, s22, 8
    s_add_u32 s57, s57, 0xc0000
    s_load_dword s57, s[18:19], s57
    buffer_load_dword v7, v31, s[40:43], 0 offen offset:1536 sc1
    s_cmp_ge_u32 s22, 6
    s_cbranch_scc1 L_q_tag
    s_add_u32 s28, s10, s50
    s_addc_u32 s29, s11, 0
    s_sub_u32 s30, 7864320, s50
    s_mov_b32 s31, 0x20000
    s_mov_b32 s36, s4
    s_mov_b32 s37, s5
    s_mov_b32 s38, 10240
    s_mov_b32 s39, 0x20000
    buffer_load_dwordx4 v[64:67], v4, s[28:31], s55 offen nt
    s_add_u32 s55, s55, 12288
    buffer_load_dwordx4 v[68:71], v4, s[28:31], s55 offen nt
    s_add_u32 s55, s55, 12288
    buffer_load_dwordx4 v[72:75], v4, s[28:31], s55 offen nt
    s_add_u32 s55, s55, 12288
    buffer_load_dwordx4 v[76:79], v4, s[28:31], s55 offen nt
    s_add_u32 s55, s55, 12288
    buffer_load_dwordx4 v[80:83], v4, s[28:31], s55 offen nt
    s_add_u32 s55, s55, 12288
    buffer_load_dwordx4 v[84:87], v4, s[28:31], s55 offen nt
    s_add_u32 s55, s55, 12288
    buffer_load_dwordx4 v[88:91], v4, s[28:31], s55 offen nt
    s_add_u32 s55, s55, 12288
    buffer_load_dwordx4 v[92:95], v4, s[28:31], s55 offen nt
    s_add_u32 s55, s55, 700416
    buffer_load_dwordx4 v[8:11], v30, s[36:39], s52 offen offset:0
    buffer_load_dwordx4 v[96:99], v4, s[28:31], s55 offen nt
    s_add_u32 s55, s55, 12288
    buffer_load_dwordx4 v[100:103], v4, s[28:31], s55 offen nt
    s_add_u32 s55, s55, 12288
    buffer_load_dwordx4 v[104:107], v4, s[28:31], s55 offen nt
    s_add_u32 s55, s55, 12288
    buffer_load_dwordx4 v[108:111], v4, s[28:31], s55 offen nt
    s_add_u32 s55, s55, 12288
    buffer_load_dwordx4 v[112:115], v4, s[28:31], s55 offen nt
    s_add_u32 s55, s55, 12288
    buffer_load_dwordx4 v[116:119], v4, s[28:31], s55 offen nt
    s_add_u32 s55, s55, 12288
    buffer_load_dwordx4 v[120:123], v4, s[28:31], s55 offen nt
    s_add_u32 s55, s55, 12288
    buffer_load_dwordx4 v[124:127], v4, s[28:31], s55 offen nt
    s_add_u32 s55, s55, 700416
    buffer_load_dwordx4 v[12:15], v30, s[36:39], s52 offen offset:128
    buffer_load_dwordx4 v[128:131], v4, s[28:31], s55 offen nt
    s_add_u32 s55, s55, 12288
    buffer_load_dwordx4 v[132:135], v4, s[28:31], s55 offen nt
    s_add_u32 s55, s55, 12288
    buffer_load_dwordx4 v[136:139], v4, s[28:31], s55 offen nt
    s_add_u32 s55, s55, 12288
    buffer_load_dwordx4 v[140:143], v4, s[28:31], s55 offen nt
    s_add_u32 s55, s55, 12288
    buffer_load_dwordx4 v[144:147], v4, s[28:31], s55 offen nt
    s_add_u32 s55, s55, 12288
    buffer_load_dwordx4 v[148:151], v4, s[28:31], s55 offen nt
    s_add_u32 s55, s55, 12288
    buffer_load_dwordx4 v[152:155], v4, s[28:31], s55 offen nt
    s_add_u32 s55, s55, 12288
    buffer_load_dwordx4 v[156:159], v4, s[28:31], s55 offen nt
    s_add_u32 s55, s55, 700416
    buffer_load_dwordx4 v[16:19], v30, s[36:39], s52 offen offset:256
    buffer_load_dwordx4 v[160:163], v4, s[28:31], s55 offen nt
    s_add_u32 s55, s55, 12288
    buffer_load_dwordx4 v[164:167], v4, s[28:31], s55 offen nt
    s_add_u32 s55, s55, 12288
    buffer_load_dwordx4 v[168:171], v4, s[28:31], s55 offen nt
    s_add_u32 s55, s55, 12288
    buffer_load_dwordx4 v[172:175], v4, s[28:31], s55 offen nt
    s_add_u32 s55, s55, 12288
    buffer_load_dwordx4 v[176:179], v4, s[28:31], s55 offen nt
    s_add_u32 s55, s55, 12288
    buffer_load_dwordx4 v[180:183], v4, s[28:31], s55 offen nt
    s_add_u32 s55, s55, 12288
    buffer_load_dwordx4 v[184:187], v4, s[28:31], s55 offen nt
    s_add_u32 s55, s55, 12288
    buffer_load_dwordx4 v[188:191], v4, s[28:31], s55 offen nt
    s_add_u32 s55, s55, 700416
    buffer_load_dwordx4 v[20:23], v30, s[36:39], s52 offen offset:384
    buffer_load_dwordx4 v[192:195], v4, s[28:31], s55 offen nt
    s_add_u32 s55, s55, 12288
    buffer_load_dwordx4 v[196:199], v4, s[28:31], s55 offen nt
    s_add_u32 s55, s55, 12288
    buffer_load_dwordx4 v[200:203], v4, s[28:31], s55 offen nt
    s_add_u32 s55, s55, 12288
    buffer_load_dwordx4 v[204:207], v4, s[28:31], s55 offen nt
    s_add_u32 s55, s55, 12288
    buffer_load_dwordx4 v[208:211], v4, s[28:31], s55 offen nt
    s_add_u32 s55, s55, 12288
    buffer_load_dwordx4 v[212:215], v4, s[28:31], s55 offen nt
    s_add_u32 s55, s55, 12288
    buffer_load_dwordx4 v[216:219], v4, s[28:31], s55 offen nt
    s_add_u32 s55, s55, 12288
    buffer_load_dwordx4 v[220:223], v4, s[28:31], s55 offen nt
    s_add_u32 s55, s55, 700416
    buffer_load_dwordx4 v[24:27], v30, s[36:39], s52 offen offset:512
    v_lshl_add_u32 v31, v29, 4, v31
    s_lshl_b32 s55, s22, 8
    s_waitcnt vmcnt(36)
    v_perm_b32 v32, v68, v64, s60
    v_perm_b32 v33, v76, v72, s60
    v_perm_b32 v34, v84, v80, s60
    v_perm_b32 v35, v92, v88, s60
    v_perm_b32 v36, v68, v64, s61
    v_perm_b32 v37, v76, v72, s61
    v_perm_b32 v38, v84, v80, s61
    v_perm_b32 v39, v92, v88, s61
    v_mfma_f32_16x16x32_bf16 v[224:227], v[32:35], v[8:11], 0
    v_perm_b32 v40, v69, v65, s60
    v_perm_b32 v41, v77, v73, s60
    v_perm_b32 v42, v85, v81, s60
    v_perm_b32 v43, v93, v89, s60
    v_mfma_f32_16x16x32_bf16 v[228:231], v[36:39], v[8:11], 0
    v_perm_b32 v44, v69, v65, s61
    v_perm_b32 v45, v77, v73, s61
    v_perm_b32 v46, v85, v81, s61
    v_perm_b32 v47, v93, v89, s61
    v_mfma_f32_16x16x32_bf16 v[232:235], v[40:43], v[8:11], 0
    v_perm_b32 v48, v70, v66, s60
    v_perm_b32 v49, v78, v74, s60
    v_perm_b32 v50, v86, v82, s60
    v_perm_b32 v51, v94, v90, s60
    v_mfma_f32_16x16x32_bf16 v[236:239], v[44:47], v[8:11], 0
    v_perm_b32 v52, v70, v66, s61
    v_perm_b32 v53, v78, v74, s61
    v_perm_b32 v54, v86, v82, s61
    v_perm_b32 v55, v94, v90, s61
    v_mfma_f32_16x16x32_bf16 v[240:243], v[48:51], v[8:11], 0
    v_perm_b32 v56, v71, v67, s60
    v_perm_b32 v57, v79, v75, s60
    v_perm_b32 v58, v87, v83, s60
    v_perm_b32 v59, v95, v91, s60
    v_mfma_f32_16x16x32_bf16 v[244:247], v[52:55], v[8:11], 0
    v_perm_b32 v60, v71, v67, s61
    v_perm_b32 v61, v79, v75, s61
    v_perm_b32 v62, v87, v83, s61
    v_perm_b32 v63, v95, v91, s61
    v_mfma_f32_16x16x32_bf16 v[248:251], v[56:59], v[8:11], 0
    s_nop 0
    v_mfma_f32_16x16x32_bf16 v[252:255], v[60:63], v[8:11], 0
    s_waitcnt vmcnt(27)
    v_perm_b32 v32, v100, v96, s60
    v_perm_b32 v33, v108, v104, s60
    v_perm_b32 v34, v116, v112, s60
    v_perm_b32 v35, v124, v120, s60
    v_perm_b32 v36, v100, v96, s61
    v_perm_b32 v37, v108, v104, s61
    v_perm_b32 v38, v116, v112, s61
    v_perm_b32 v39, v124, v120, s61
    v_mfma_f32_16x16x32_bf16 v[224:227], v[32:35], v[12:15], v[224:227]
    v_perm_b32 v40, v101, v97, s60
    v_perm_b32 v41, v109, v105, s60
    v_perm_b32 v42, v117, v113, s60
    v_perm_b32 v43, v125, v121, s60
    v_mfma_f32_16x16x32_bf16 v[228:231], v[36:39], v[12:15], v[228:231]
    v_perm_b32 v44, v101, v97, s61
    v_perm_b32 v45, v109, v105, s61
    v_perm_b32 v46, v117, v113, s61
    v_perm_b32 v47, v125, v121, s61
    v_mfma_f32_16x16x32_bf16 v[232:235], v[40:43], v[12:15], v[232:235]
    v_perm_b32 v48, v102, v98, s60
    v_perm_b32 v49, v110, v106, s60
    v_perm_b32 v50, v118, v114, s60
    v_perm_b32 v51, v126, v122, s60
    v_mfma_f32_16x16x32_bf16 v[236:239], v[44:47], v[12:15], v[236:239]
    v_perm_b32 v52, v102, v98, s61
    v_perm_b32 v53, v110, v106, s61
    v_perm_b32 v54, v118, v114, s61
    v_perm_b32 v55, v126, v122, s61
    v_mfma_f32_16x16x32_bf16 v[240:243], v[48:51], v[12:15], v[240:243]
    v_perm_b32 v56, v103, v99, s60
    v_perm_b32 v57, v111, v107, s60
    v_perm_b32 v58, v119, v115, s60
    v_perm_b32 v59, v127, v123, s60
    v_mfma_f32_16x16x32_bf16 v[244:247], v[52:55], v[12:15], v[244:247]
    v_perm_b32 v60, v103, v99, s61
    v_perm_b32 v61, v111, v107, s61
    v_perm_b32 v62, v119, v115, s61
    v_perm_b32 v63, v127, v123, s61
    v_mfma_f32_16x16x32_bf16 v[248:251], v[56:59], v[12:15], v[248:251]
    s_nop 0
    v_mfma_f32_16x16x32_bf16 v[252:255], v[60:63], v[12:15], v[252:255]
    s_waitcnt vmcnt(18)
    v_perm_b32 v32, v132, v128, s60
    v_perm_b32 v33, v140, v136, s60
    v_perm_b32 v34, v148, v144, s60
    v_perm_b32 v35, v156, v152, s60
    v_perm_b32 v36, v132, v128, s61
    v_perm_b32 v37, v140, v136, s61
    v_perm_b32 v38, v148, v144, s61
    v_perm_b32 v39, v156, v152, s61
    v_mfma_f32_16x16x32_bf16 v[224:227], v[32:35], v[16:19], v[224:227]
    v_perm_b32 v40, v133, v129, s60
    v_perm_b32 v41, v141, v137, s60
    v_perm_b32 v42, v149, v145, s60
    v_perm_b32 v43, v157, v153, s60
    v_mfma_f32_16x16x32_bf16 v[228:231], v[36:39], v[16:19], v[228:231]
    v_perm_b32 v44, v133, v129, s61
    v_perm_b32 v45, v141, v137, s61
    v_perm_b32 v46, v149, v145, s61
    v_perm_b32 v47, v157, v153, s61
    v_mfma_f32_16x16x32_bf16 v[232:235], v[40:43], v[16:19], v[232:235]
    v_perm_b32 v48, v134, v130, s60
    v_perm_b32 v49, v142, v138, s60
    v_perm_b32 v50, v150, v146, s60
    v_perm_b32 v51, v158, v154, s60
    v_mfma_f32_16x16x32_bf16 v[236:239], v[44:47], v[16:19], v[236:239]
    v_perm_b32 v52, v134, v130, s61
    v_perm_b32 v53, v142, v138, s61
    v_perm_b32 v54, v150, v146, s61
    v_perm_b32 v55, v158, v154, s61
    v_mfma_f32_16x16x32_bf16 v[240:243], v[48:51], v[16:19], v[240:243]
    v_perm_b32 v56, v135, v131, s60
    v_perm_b32 v57, v143, v139, s60
    v_perm_b32 v58, v151, v147, s60
    v_perm_b32 v59, v159, v155, s60
    v_mfma_f32_16x16x32_bf16 v[244:247], v[52:55], v[16:19], v[244:247]
    v_perm_b32 v60, v135, v131, s61
    v_perm_b32 v61, v143, v139, s61
    v_perm_b32 v62, v151, v147, s61
    v_perm_b32 v63, v159, v155, s61
    v_mfma_f32_16x16x32_bf16 v[248:251], v[56:59], v[16:19], v[248:251]
    s_nop 0
    v_mfma_f32_16x16x32_bf16 v[252:255], v[60:63], v[16:19], v[252:255]
    s_waitcnt vmcnt(9)
    v_perm_b32 v32, v164, v160, s60
    v_perm_b32 v33, v172, v168, s60
    v_perm_b32 v34, v180, v176, s60
    v_perm_b32 v35, v188, v184, s60
    v_perm_b32 v36, v164, v160, s61
    v_perm_b32 v37, v172, v168, s61
    v_perm_b32 v38, v180, v176, s61
    v_perm_b32 v39, v188, v184, s61
    v_mfma_f32_16x16x32_bf16 v[224:227], v[32:35], v[20:23], v[224:227]
    v_perm_b32 v40, v165, v161, s60
    v_perm_b32 v41, v173, v169, s60
    v_perm_b32 v42, v181, v177, s60
    v_perm_b32 v43, v189, v185, s60
    v_mfma_f32_16x16x32_bf16 v[228:231], v[36:39], v[20:23], v[228:231]
    v_perm_b32 v44, v165, v161, s61
    v_perm_b32 v45, v173, v169, s61
    v_perm_b32 v46, v181, v177, s61
    v_perm_b32 v47, v189, v185, s61
    v_mfma_f32_16x16x32_bf16 v[232:235], v[40:43], v[20:23], v[232:235]
    v_perm_b32 v48, v166, v162, s60
    v_perm_b32 v49, v174, v170, s60
    v_perm_b32 v50, v182, v178, s60
    v_perm_b32 v51, v190, v186, s60
    v_mfma_f32_16x16x32_bf16 v[236:239], v[44:47], v[20:23], v[236:239]
    v_perm_b32 v52, v166, v162, s61
    v_perm_b32 v53, v174, v170, s61
    v_perm_b32 v54, v182, v178, s61
    v_perm_b32 v55, v190, v186, s61
    v_mfma_f32_16x16x32_bf16 v[240:243], v[48:51], v[20:23], v[240:243]
    v_perm_b32 v56, v167, v163, s60
    v_perm_b32 v57, v175, v171, s60
    v_perm_b32 v58, v183, v179, s60
    v_perm_b32 v59, v191, v187, s60
    v_mfma_f32_16x16x32_bf16 v[244:247], v[52:55], v[20:23], v[244:247]
    v_perm_b32 v60, v167, v163, s61
    v_perm_b32 v61, v175, v171, s61
    v_perm_b32 v62, v183, v179, s61
    v_perm_b32 v63, v191, v187, s61
    v_mfma_f32_16x16x32_bf16 v[248:251], v[56:59], v[20:23], v[248:251]
    s_nop 0
    v_mfma_f32_16x16x32_bf16 v[252:255], v[60:63], v[20:23], v[252:255]
    s_waitcnt vmcnt(0)
    v_perm_b32 v32, v196, v192, s60
    v_perm_b32 v33, v204, v200, s60
    v_perm_b32 v34, v212, v208, s60
    v_perm_b32 v35, v220, v216, s60
    v_perm_b32 v36, v196, v192, s61
    v_perm_b32 v37, v204, v200, s61
    v_perm_b32 v38, v212, v208, s61
    v_perm_b32 v39, v220, v216, s61
    v_mfma_f32_16x16x32_bf16 v[224:227], v[32:35], v[24:27], v[224:227]
    v_perm_b32 v40, v197, v193, s60
    v_perm_b32 v41, v205, v201, s60
    v_perm_b32 v42, v213, v209, s60
    v_perm_b32 v43, v221, v217, s60
    v_mfma_f32_16x16x32_bf16 v[228:231], v[36:39], v[24:27], v[228:231]
    v_perm_b32 v44, v197, v193, s61
    v_perm_b32 v45, v205, v201, s61
    v_perm_b32 v46, v213, v209, s61
    v_perm_b32 v47, v221, v217, s61
    v_mfma_f32_16x16x32_bf16 v[232:235], v[40:43], v[24:27], v[232:235]
    v_perm_b32 v48, v198, v194, s60
    v_perm_b32 v49, v206, v202, s60
    v_perm_b32 v50, v214, v210, s60
    v_perm_b32 v51, v222, v218, s60
    v_mfma_f32_16x16x32_bf16 v[236:239], v[44:47], v[24:27], v[236:239]
    v_perm_b32 v52, v198, v194, s61
    v_perm_b32 v53, v206, v202, s61
    v_perm_b32 v54, v214, v210, s61
    v_perm_b32 v55, v222, v218, s61
    v_mfma_f32_16x16x32_bf16 v[240:243], v[48:51], v[24:27], v[240:243]
    v_perm_b32 v56, v199, v195, s60
    v_perm_b32 v57, v207, v203, s60
    v_perm_b32 v58, v215, v211, s60
    v_perm_b32 v59, v223, v219, s60
    v_mfma_f32_16x16x32_bf16 v[244:247], v[52:55], v[24:27], v[244:247]
    v_perm_b32 v60, v199, v195, s61
    v_perm_b32 v61, v207, v203, s61
    v_perm_b32 v62, v215, v211, s61
    v_perm_b32 v63, v223, v219, s61
    v_mfma_f32_16x16x32_bf16 v[248:251], v[56:59], v[24:27], v[248:251]
    s_nop 0
    v_mfma_f32_16x16x32_bf16 v[252:255], v[60:63], v[24:27], v[252:255]
    v_add_u32 v7, 0x11111111, v7
    v_lshrrev_b32 v17, 4, v7
    v_lshrrev_b32 v18, 8, v7
    v_lshrrev_b32 v19, 12, v7
    v_lshrrev_b32 v20, 16, v7
    v_lshrrev_b32 v21, 20, v7
    v_lshrrev_b32 v22, 24, v7
    v_lshrrev_b32 v23, 28, v7
    v_permlane32_swap_b32 v224, v240
    v_permlane32_swap_b32 v225, v241
    v_permlane32_swap_b32 v226, v242
    v_permlane32_swap_b32 v227, v243
    v_permlane32_swap_b32 v228, v244
    v_permlane32_swap_b32 v229, v245
    v_permlane32_swap_b32 v230, v246
    v_permlane32_swap_b32 v231, v247
    v_permlane32_swap_b32 v232, v248
    v_permlane32_swap_b32 v233, v249
    v_permlane32_swap_b32 v234, v250
    v_permlane32_swap_b32 v235, v251
    v_permlane32_swap_b32 v236, v252
    v_permlane32_swap_b32 v237, v253
    v_permlane32_swap_b32 v238, v254
    v_permlane32_swap_b32 v239, v255
    v_add_f32_dpp v8, v240, v224 row_ror:8 row_mask:0xf bank_mask:0x3
    v_add_f32_dpp v9, v241, v225 row_ror:8 row_mask:0xf bank_mask:0x3
    v_add_f32_dpp v10, v242, v226 row_ror:8 row_mask:0xf bank_mask:0x3
    v_add_f32_dpp v11, v243, v227 row_ror:8 row_mask:0xf bank_mask:0x3
    v_add_f32_dpp v12, v248, v232 row_ror:8 row_mask:0xf bank_mask:0x3
    v_add_f32_dpp v13, v249, v233 row_ror:8 row_mask:0xf bank_mask:0x3
    v_add_f32_dpp v14, v250, v234 row_ror:8 row_mask:0xf bank_mask:0x3
    v_add_f32_dpp v15, v251, v235 row_ror:8 row_mask:0xf bank_mask:0x3
    v_add_f32_dpp v8, v228, v244 row_ror:8 row_mask:0xf bank_mask:0xc
    v_add_f32_dpp v9, v229, v245 row_ror:8 row_mask:0xf bank_mask:0xc
    v_add_f32_dpp v10, v230, v246 row_ror:8 row_mask:0xf bank_mask:0xc
    v_add_f32_dpp v11, v231, v247 row_ror:8 row_mask:0xf bank_mask:0xc
    v_add_f32_dpp v12, v236, v252 row_ror:8 row_mask:0xf bank_mask:0xc
    v_add_f32_dpp v13, v237, v253 row_ror:8 row_mask:0xf bank_mask:0xc
    v_add_f32_dpp v14, v238, v254 row_ror:8 row_mask:0xf bank_mask:0xc
    v_add_f32_dpp v15, v239, v255 row_ror:8 row_mask:0xf bank_mask:0xc
    v_bfi_b32 v8, 15, v7, v8
    v_bfi_b32 v9, 15, v17, v9
    v_bfi_b32 v10, 15, v18, v10
    v_bfi_b32 v11, 15, v19, v11
    buffer_store_dwordx4 v[8:11], v31, s[40:43], s55 offen offset:0 sc1
    v_bfi_b32 v12, 15, v20, v12
    v_bfi_b32 v13, 15, v21, v13
    v_bfi_b32 v14, 15, v22, v14
    v_bfi_b32 v15, 15, v23, v15
    buffer_store_dwordx4 v[12:15], v31, s[40:43], s55 offen offset:128 sc1
    s_branch L_q_gather
L_q_tag:
    s_waitcnt vmcnt(0)
    v_add_u32 v7, 0x11111111, v7
L_q_gather:
    v_lshlrev_b32 v1, 4, v0
    v_readlane_b32 s56, v7, s22
    s_lshl_b32 s55, s22, 11
    s_mov_b32 s59, 0
    v_bfe_u32 v2, v0, 3, 1
    v_lshlrev_b32 v2, 4, v2
    v_lshrrev_b32 v28, v2, s56
    v_lshrrev_b32 v29, 4, v28
    v_lshrrev_b32 v30, 8, v28
    v_lshrrev_b32 v31, 12, v28
    s_mov_b32 exec_hi, 0xffff
    s_barrier
L_q_poll:
    buffer_load_dwordx4 v[16:19], v1, s[40:43], s55 offen sc1
    buffer_load_dwordx4 v[20:23], v1, s[40:43], s55 offen offset:768 sc1
    s_add_u32 s59, s59, 1
    s_waitcnt vmcnt(0)
    v_xor_b32 v24, v16, v28
    v_xor_b32 v25, v17, v29
    v_xor_b32 v26, v18, v30
    v_xor_b32 v27, v19, v31
    v_or3_b32 v24, v24, v25, v26
    v_xor_b32 v25, v20, v28
    v_xor_b32 v26, v21, v29
    v_xor_b32 v3, v22, v30
    v_or3_b32 v24, v24, v27, v25
    v_xor_b32 v25, v23, v31
    v_or3_b32 v24, v24, v26, v3
    v_or_b32 v24, v24, v25
    v_and_b32 v24, 15, v24
    v_cmp_ne_u32 vcc, 0, v24
    s_cbranch_vccz L_q_got
    s_sleep 16
    s_cmp_lt_u32 s59, 0x100000
    s_cbranch_scc1 L_q_poll
L_q_got:
    v_lshrrev_b32 v2, 4, v0
    v_lshlrev_b32 v2, 6, v2
    v_and_b32 v3, 1, v0
    v_lshl_add_u32 v2, v3, 5, v2
    v_bfe_u32 v3, v0, 2, 2
    v_add_u32 v2, v2, v3
    v_bfe_u32 v3, v0, 1, 1
    v_lshl_add_u32 v2, v3, 2, v2
    v_lshlrev_b32 v2, 1, v2
    v_add_u32 v2, 143360, v2
    v_bfi_b32 v16, 15, 8, v16
    v_bfi_b32 v17, 15, 8, v17
    v_bfi_b32 v18, 15, 8, v18
    v_bfi_b32 v19, 15, 8, v19
    v_bfi_b32 v20, 15, 8, v20
    v_bfi_b32 v21, 15, 8, v21
    v_bfi_b32 v22, 15, 8, v22
    v_bfi_b32 v23, 15, 8, v23
    v_add_f32 v16, v16, v20
    v_add_f32 v17, v17, v21
    v_add_f32 v18, v18, v22
    v_add_f32 v19, v19, v23
    v_cvt_pk_bf16_f32 v16, v16, v17
    v_cvt_pk_bf16_f32 v18, v18, v19
    ds_write_b16 v2, v16
    ds_write_b16_d16_hi v2, v16 offset:16
    ds_write_b16 v2, v18 offset:32
    ds_write_b16_d16_hi v2, v18 offset:48
    v_mov_b32 v3, s56
    s_mov_b64 exec, 1
    buffer_store_dword v3, v1, s[40:43], s55 offen offset:1536 sc1
    s_mov_b64 exec, -1
    s_branch L_h_go
L_h_setup:
    s_waitcnt lgkmcnt(0)
    s_lshl_b32 s57, s22, 8
    s_add_u32 s57, s57, 0xc0000
    s_load_dword s57, s[18:19], s57
    s_barrier
L_h_go:
    s_and_b32 s50, s2, 7
    s_lshl_b32 s50, s50, 12
    s_add_u32 s50, s50, 0x200080
    v_mov_b32 v24, s50
    v_add_u32 v25, 1920, v24
    v_mov_b32 v26, 0
    s_lshl_b32 s51, s23, 3
    s_add_u32 s51, s51, s54
    s_cmp_lg_u32 s51, 1
    s_cbranch_scc1 L_m_noinit
    s_mov_b64 exec, 1
    global_store_dword v24, v26, s[18:19]
    s_mov_b64 exec, -1
L_m_noinit:
    s_waitcnt lgkmcnt(0)
    s_barrier
    s_add_u32 s57, s57, 0x01010101
    s_mul_i32 s50, s21, 245760
    s_add_u32 s32, s12, s50
    s_addc_u32 s33, s13, 0
    s_mov_b32 s34, 245760
    s_mov_b32 s35, 0x20000
    s_mul_i32 s50, s22, 81920
    s_add_u32 s40, s18, s50
    s_addc_u32 s41, s19, 0
    s_mov_b32 s42, 81920
    s_mov_b32 s43, 0x20000
    v_lshrrev_b32 v1, 4, v0
    v_and_b32 v2, 15, v0
    v_mul_u32_u24 v5, 10240, v1
    v_lshl_add_u32 v5, v2, 4, v5
    s_lshl_b32 s50, s54, 8
    v_add_u32 v5, s50, v5
    v_bfe_u32 v3, v0, 2, 2
    v_lshlrev_b32 v6, 12, v3
    v_and_b32 v3, 3, v0
    v_lshl_add_u32 v6, v3, 5, v6
    v_lshl_add_u32 v6, v1, 4, v6
    s_lshl_b32 s50, s54, 14
    s_lshl_b32 s51, s21, 7
    s_add_u32 s50, s50, s51
    v_add_u32 v6, s50, v6
    v_mov_b32 v7, s57
    s_mov_b32 s58, 14
L_h_idle1904:
    s_barrier
    s_sub_u32 s58, s58, 1
    s_cmp_lg_u32 s58, 0
    s_cbranch_scc1 L_h_idle1904
    s_mov_b32 s55, 0
    buffer_load_dwordx4 v[64:67], v5, s[32:35], s55 offen offset:0 nt
    s_barrier
    buffer_load_dwordx4 v[68:71], v5, s[32:35], s55 offen offset:1280 nt
    s_barrier
    buffer_load_dwordx4 v[72:75], v5, s[32:35], s55 offen offset:2560 nt
    s_barrier
    buffer_load_dwordx4 v[76:79], v5, s[32:35], s55 offen offset:3840 nt
    s_barrier
    s_mov_b32 s55, 5120
    buffer_load_dwordx4 v[80:83], v5, s[32:35], s55 offen offset:0 nt
    s_barrier
    buffer_load_dwordx4 v[84:87], v5, s[32:35], s55 offen offset:1280 nt
    s_barrier
    buffer_load_dwordx4 v[88:91], v5, s[32:35], s55 offen offset:2560 nt
    s_barrier
    buffer_load_dwordx4 v[92:95], v5, s[32:35], s55 offen offset:3840 nt
    s_barrier
    s_mov_b32 s55, 40960
    buffer_load_dwordx4 v[96:99], v5, s[32:35], s55 offen offset:0 nt
    s_barrier
    buffer_load_dwordx4 v[100:103], v5, s[32:35], s55 offen offset:1280 nt
    s_barrier
    buffer_load_dwordx4 v[104:107], v5, s[32:35], s55 offen offset:2560 nt
    s_barrier
    buffer_load_dwordx4 v[108:111], v5, s[32:35], s55 offen offset:3840 nt
    s_barrier
    s_mov_b32 s55, 46080
    buffer_load_dwordx4 v[112:115], v5, s[32:35], s55 offen offset:0 nt
    s_barrier
    buffer_load_dwordx4 v[116:119], v5, s[32:35], s55 offen offset:1280 nt
    s_barrier
    buffer_load_dwordx4 v[120:123], v5, s[32:35], s55 offen offset:2560 nt
    s_barrier
    buffer_load_dwordx4 v[124:127], v5, s[32:35], s55 offen offset:3840 nt
    s_barrier
    s_mov_b32 s55, 81920
    buffer_load_dwordx4 v[128:131], v5, s[32:35], s55 offen offset:0 nt
    s_barrier
    buffer_load_dwordx4 v[132:135], v5, s[32:35], s55 offen offset:1280 nt
    s_barrier
    buffer_load_dwordx4 v[136:139], v5, s[32:35], s55 offen offset:2560 nt
    s_barrier
    buffer_load_dwordx4 v[140:143], v5, s[32:35], s55 offen offset:3840 nt
    s_barrier
    s_mov_b32 s55, 87040
    buffer_load_dwordx4 v[144:147], v5, s[32:35], s55 offen offset:0 nt
    s_barrier
    buffer_load_dwordx4 v[148:151], v5, s[32:35], s55 offen offset:1280 nt
    s_barrier
    buffer_load_dwordx4 v[152:155], v5, s[32:35], s55 offen offset:2560 nt
    s_barrier
    buffer_load_dwordx4 v[156:159], v5, s[32:35], s55 offen offset:3840 nt
    s_barrier
    s_mov_b32 s55, 122880
    buffer_load_dwordx4 v[160:163], v5, s[32:35], s55 offen offset:0 nt
    s_barrier
    buffer_load_dwordx4 v[164:167], v5, s[32:35], s55 offen offset:1280 nt
    s_barrier
    buffer_load_dwordx4 v[168:171], v5, s[32:35], s55 offen offset:2560 nt
    s_barrier
    buffer_load_dwordx4 v[172:175], v5, s[32:35], s55 offen offset:3840 nt
    s_barrier
    s_mov_b32 s55, 128000
    buffer_load_dwordx4 v[176:179], v5, s[32:35], s55 offen offset:0 nt
    s_barrier
    buffer_load_dwordx4 v[180:183], v5, s[32:35], s55 offen offset:1280 nt
    s_barrier
    buffer_load_dwordx4 v[184:187], v5, s[32:35], s55 offen offset:2560 nt
    s_barrier
    buffer_load_dwordx4 v[188:191], v5, s[32:35], s55 offen offset:3840 nt
    s_barrier
    s_mov_b32 s55, 163840
    buffer_load_dwordx4 v[192:195], v5, s[32:35], s55 offen offset:0 nt
    s_barrier
    buffer_load_dwordx4 v[196:199], v5, s[32:35], s55 offen offset:1280 nt
    s_barrier
    buffer_load_dwordx4 v[200:203], v5, s[32:35], s55 offen offset:2560 nt
    s_barrier
    buffer_load_dwordx4 v[204:207], v5, s[32:35], s55 offen offset:3840 nt
    s_barrier
    s_mov_b32 s55, 168960
    buffer_load_dwordx4 v[208:211], v5, s[32:35], s55 offen offset:0 nt
    s_barrier
    buffer_load_dwordx4 v[212:215], v5, s[32:35], s55 offen offset:1280 nt
    s_barrier
    buffer_load_dwordx4 v[216:219], v5, s[32:35], s55 offen offset:2560 nt
    s_barrier
    buffer_load_dwordx4 v[220:223], v5, s[32:35], s55 offen offset:3840 nt
    s_barrier
    s_mov_b32 s55, 204800
    buffer_load_dwordx4 v[224:227], v5, s[32:35], s55 offen offset:0 nt
    s_barrier
    buffer_load_dwordx4 v[228:231], v5, s[32:35], s55 offen offset:1280 nt
    s_barrier
    buffer_load_dwordx4 v[232:235], v5, s[32:35], s55 offen offset:2560 nt
    s_barrier
    buffer_load_dwordx4 v[236:239], v5, s[32:35], s55 offen offset:3840 nt
    s_barrier
    s_mov_b32 s55, 209920
    buffer_load_dwordx4 v[240:243], v5, s[32:35], s55 offen offset:0 nt
    s_barrier
    buffer_load_dwordx4 v[244:247], v5, s[32:35], s55 offen offset:1280 nt
    s_barrier
    buffer_load_dwordx4 v[248:251], v5, s[32:35], s55 offen offset:2560 nt
    s_barrier
    buffer_load_dwordx4 v[252:255], v5, s[32:35], s55 offen offset:3840 nt
    s_barrier
    s_mov_b32 s58, 8
L_h_idle2018:
    s_barrier
    s_sub_u32 s58, s58, 1
    s_cmp_lg_u32 s58, 0
    s_cbranch_scc1 L_h_idle2018
    s_waitcnt vmcnt(0)
    v_perm_b32 v32, v68, v64, s60
    v_perm_b32 v33, v76, v72, s60
    v_perm_b32 v34, v84, v80, s60
    v_perm_b32 v35, v92, v88, s60
    v_perm_b32 v36, v68, v64, s61
    v_perm_b32 v37, v76, v72, s61
    v_perm_b32 v38, v84, v80, s61
    v_perm_b32 v39, v92, v88, s61
    v_perm_b32 v40, v69, v65, s60
    v_perm_b32 v41, v77, v73, s60
    v_perm_b32 v42, v85, v81, s60
    v_perm_b32 v43, v93, v89, s60
    v_perm_b32 v44, v69, v65, s61
    v_perm_b32 v45, v77, v73, s61
    v_perm_b32 v46, v85, v81, s61
    v_perm_b32 v47, v93, v89, s61
    v_perm_b32 v48, v70, v66, s60
    v_perm_b32 v49, v78, v74, s60
    v_perm_b32 v50, v86, v82, s60
    v_perm_b32 v51, v94, v90, s60
    v_perm_b32 v52, v70, v66, s61
    v_perm_b32 v53, v78, v74, s61
    v_perm_b32 v54, v86, v82, s61
    v_perm_b32 v55, v94, v90, s61
    v_perm_b32 v56, v71, v67, s60
    v_perm_b32 v57, v79, v75, s60
    v_perm_b32 v58, v87, v83, s60
    v_perm_b32 v59, v95, v91, s60
    v_perm_b32 v60, v71, v67, s61
    v_perm_b32 v61, v79, v75, s61
    v_perm_b32 v62, v87, v83, s61
    v_perm_b32 v63, v95, v91, s61
    s_barrier
    v_perm_b32 v64, v100, v96, s60
    v_perm_b32 v65, v108, v104, s60
    v_perm_b32 v66, v116, v112, s60
    v_perm_b32 v67, v124, v120, s60
    v_perm_b32 v68, v100, v96, s61
    v_perm_b32 v69, v108, v104, s61
    v_perm_b32 v70, v116, v112, s61
    v_perm_b32 v71, v124, v120, s61
    v_perm_b32 v72, v101, v97, s60
    v_perm_b32 v73, v109, v105, s60
    v_perm_b32 v74, v117, v113, s60
    v_perm_b32 v75, v125, v121, s60
    v_perm_b32 v76, v101, v97, s61
    v_perm_b32 v77, v109, v105, s61
    v_perm_b32 v78, v117, v113, s61
    v_perm_b32 v79, v125, v121, s61
    v_perm_b32 v80, v102, v98, s60
    v_perm_b32 v81, v110, v106, s60
    v_perm_b32 v82, v118, v114, s60
    v_perm_b32 v83, v126, v122, s60
    v_perm_b32 v84, v102, v98, s61
    v_perm_b32 v85, v110, v106, s61
    v_perm_b32 v86, v118, v114, s61
    v_perm_b32 v87, v126, v122, s61
    v_perm_b32 v88, v103, v99, s60
    v_perm_b32 v89, v111, v107, s60
    v_perm_b32 v90, v119, v115, s60
    v_perm_b32 v91, v127, v123, s60
    v_perm_b32 v92, v103, v99, s61
    v_perm_b32 v93, v111, v107, s61
    v_perm_b32 v94, v119, v115, s61
    v_perm_b32 v95, v127, v123, s61
    s_barrier
    v_perm_b32 v96, v132, v128, s60
    v_perm_b32 v97, v140, v136, s60
    v_perm_b32 v98, v148, v144, s60
    v_perm_b32 v99, v156, v152, s60
    v_perm_b32 v100, v132, v128, s61
    v_perm_b32 v101, v140, v136, s61
    v_perm_b32 v102, v148, v144, s61
    v_perm_b32 v103, v156, v152, s61
    v_perm_b32 v104, v133, v129, s60
    v_perm_b32 v105, v141, v137, s60
    v_perm_b32 v106, v149, v145, s60
    v_perm_b32 v107, v157, v153, s60
    v_perm_b32 v108, v133, v129, s61
    v_perm_b32 v109, v141, v137, s61
    v_perm_b32 v110, v149, v145, s61
    v_perm_b32 v111, v157, v153, s61
    v_perm_b32 v112, v134, v130, s60
    v_perm_b32 v113, v142, v138, s60
    v_perm_b32 v114, v150, v146, s60
    v_perm_b32 v115, v158, v154, s60
    v_perm_b32 v116, v134, v130, s61
    v_perm_b32 v117, v142, v138, s61
    v_perm_b32 v118, v150, v146, s61
    v_perm_b32 v119, v158, v154, s61
    v_perm_b32 v120, v135, v131, s60
    v_perm_b32 v121, v143, v139, s60
    v_perm_b32 v122, v151, v147, s60
    v_perm_b32 v123, v159, v155, s60
    v_perm_b32 v124, v135, v131, s61
    v_perm_b32 v125, v143, v139, s61
    v_perm_b32 v126, v151, v147, s61
    v_perm_b32 v127, v159, v155, s61
    s_barrier
    v_perm_b32 v128, v164, v160, s60
    v_perm_b32 v129, v172, v168, s60
    v_perm_b32 v130, v180, v176, s60
    v_perm_b32 v131, v188, v184, s60
    v_perm_b32 v132, v164, v160, s61
    v_perm_b32 v133, v172, v168, s61
    v_perm_b32 v134, v180, v176, s61
    v_perm_b32 v135, v188, v184, s61
    v_perm_b32 v136, v165, v161, s60
    v_perm_b32 v137, v173, v169, s60
    v_perm_b32 v138, v181, v177, s60
    v_perm_b32 v139, v189, v185, s60
    v_perm_b32 v140, v165, v161, s61
    v_perm_b32 v141, v173, v169, s61
    v_perm_b32 v142, v181, v177, s61
    v_perm_b32 v143, v189, v185, s61
    v_perm_b32 v144, v166, v162, s60
    v_perm_b32 v145, v174, v170, s60
    v_perm_b32 v146, v182, v178, s60
    v_perm_b32 v147, v190, v186, s60
    v_perm_b32 v148, v166, v162, s61
    v_perm_b32 v149, v174, v170, s61
    v_perm_b32 v150, v182, v178, s61
    v_perm_b32 v151, v190, v186, s61
    v_perm_b32 v152, v167, v163, s60
    v_perm_b32 v153, v175, v171, s60
    v_perm_b32 v154, v183, v179, s60
    v_perm_b32 v155, v191, v187, s60
    v_perm_b32 v156, v167, v163, s61
    v_perm_b32 v157, v175, v171, s61
    v_perm_b32 v158, v183, v179, s61
    v_perm_b32 v159, v191, v187, s61
    s_barrier
    v_perm_b32 v160, v196, v192, s60
    v_perm_b32 v161, v204, v200, s60
    v_perm_b32 v162, v212, v208, s60
    v_perm_b32 v163, v220, v216, s60
    v_perm_b32 v164, v196, v192, s61
    v_perm_b32 v165, v204, v200, s61
    v_perm_b32 v166, v212, v208, s61
    v_perm_b32 v167, v220, v216, s61
    v_perm_b32 v168, v197, v193, s60
    v_perm_b32 v169, v205, v201, s60
    v_perm_b32 v170, v213, v209, s60
    v_perm_b32 v171, v221, v217, s60
    v_perm_b32 v172, v197, v193, s61
    v_perm_b32 v173, v205, v201, s61
    v_perm_b32 v174, v213, v209, s61
    v_perm_b32 v175, v221, v217, s61
    v_perm_b32 v176, v198, v194, s60
    v_perm_b32 v177, v206, v202, s60
    v_perm_b32 v178, v214, v210, s60
    v_perm_b32 v179, v222, v218, s60
    v_perm_b32 v180, v198, v194, s61
    v_perm_b32 v181, v206, v202, s61
    v_perm_b32 v182, v214, v210, s61
    v_perm_b32 v183, v222, v218, s61
    v_perm_b32 v184, v199, v195, s60
    v_perm_b32 v185, v207, v203, s60
    v_perm_b32 v186, v215, v211, s60
    v_perm_b32 v187, v223, v219, s60
    v_perm_b32 v188, v199, v195, s61
    v_perm_b32 v189, v207, v203, s61
    v_perm_b32 v190, v215, v211, s61
    v_perm_b32 v191, v223, v219, s61
    s_barrier
    v_perm_b32 v192, v228, v224, s60
    v_perm_b32 v193, v236, v232, s60
    v_perm_b32 v194, v244, v240, s60
    v_perm_b32 v195, v252, v248, s60
    v_perm_b32 v196, v228, v224, s61
    v_perm_b32 v197, v236, v232, s61
    v_perm_b32 v198, v244, v240, s61
    v_perm_b32 v199, v252, v248, s61
    v_perm_b32 v200, v229, v225, s60
    v_perm_b32 v201, v237, v233, s60
    v_perm_b32 v202, v245, v241, s60
    v_perm_b32 v203, v253, v249, s60
    v_perm_b32 v204, v229, v225, s61
    v_perm_b32 v205, v237, v233, s61
    v_perm_b32 v206, v245, v241, s61
    v_perm_b32 v207, v253, v249, s61
    v_perm_b32 v208, v230, v226, s60
    v_perm_b32 v209, v238, v234, s60
    v_perm_b32 v210, v246, v242, s60
    v_perm_b32 v211, v254, v250, s60
    v_perm_b32 v212, v230, v226, s61
    v_perm_b32 v213, v238, v234, s61
    v_perm_b32 v214, v246, v242, s61
    v_perm_b32 v215, v254, v250, s61
    v_perm_b32 v216, v231, v227, s60
    v_perm_b32 v217, v239, v235, s60
    v_perm_b32 v218, v247, v243, s60
    v_perm_b32 v219, v255, v251, s60
    v_perm_b32 v220, v231, v227, s61
    v_perm_b32 v221, v239, v235, s61
    v_perm_b32 v222, v247, v243, s61
    v_perm_b32 v223, v255, v251, s61
    s_barrier
    v_lshrrev_b32 v1, 4, v0
    v_lshlrev_b32 v1, 4, v1
    v_add_u32 v1, 135168, v1
    s_lshl_b32 s51, s23, 3
    s_add_u32 s51, s51, s54
    s_cmp_lg_u32 s51, 1
    s_cbranch_scc1 L_m_idle
    s_add_u32 s50, s2, 0
    s_and_b32 s50, s50, 7
    s_lshl_b32 s50, s50, 12
    s_add_u32 s4, s50, 0x200800
    s_load_dword s24, s[18:19], s4 glc
    s_add_u32 s50, s2, 1
    s_and_b32 s50, s50, 7
    s_lshl_b32 s50, s50, 12
    s_add_u32 s5, s50, 0x200800
    s_load_dword s25, s[18:19], s5 glc
    s_add_u32 s50, s2, 2
    s_and_b32 s50, s50, 7
    s_lshl_b32 s50, s50, 12
    s_add_u32 s6, s50, 0x200800
    s_load_dword s26, s[18:19], s6 glc
    s_add_u32 s50, s2, 3
    s_and_b32 s50, s50, 7
    s_lshl_b32 s50, s50, 12
    s_add_u32 s7, s50, 0x200800
    s_load_dword s27, s[18:19], s7 glc
    s_add_u32 s50, s2, 4
    s_and_b32 s50, s50, 7
    s_lshl_b32 s50, s50, 12
    s_add_u32 s8, s50, 0x200800
    s_load_dword s28, s[18:19], s8 glc
    s_add_u32 s50, s2, 5
    s_and_b32 s50, s50, 7
    s_lshl_b32 s50, s50, 12
    s_add_u32 s9, s50, 0x200800
    s_load_dword s29, s[18:19], s9 glc
    s_add_u32 s50, s2, 6
    s_and_b32 s50, s50, 7
    s_lshl_b32 s50, s50, 12
    s_add_u32 s10, s50, 0x200800
    s_load_dword s30, s[18:19], s10 glc
    s_add_u32 s50, s2, 7
    s_and_b32 s50, s50, 7
    s_lshl_b32 s50, s50, 12
    s_add_u32 s11, s50, 0x200800
    s_load_dword s31, s[18:19], s11 glc
    v_mov_b32 v27, 143876
    s_mov_b32 s62, 77
    s_mov_b32 s63, 1
    s_mov_b32 s59, 51
    s_mov_b64 exec, 1
    s_mov_b32 s58, 3
L_h_idle2277:
    s_barrier
    s_sub_u32 s58, s58, 1
    s_cmp_lg_u32 s58, 0
    s_cbranch_scc1 L_h_idle2277
    s_waitcnt lgkmcnt(0)
    s_mov_b32 s32, s24
    s_mov_b32 s44, 0
    s_mov_b32 s33, s25
    s_mov_b32 s45, 0
    s_mov_b32 s34, s26
    s_mov_b32 s46, 0
    s_mov_b32 s35, s27
    s_mov_b32 s47, 0
    s_mov_b32 s36, s28
    s_mov_b32 s13, 0
    s_mov_b32 s37, s29
    s_mov_b32 s14, 0
    s_mov_b32 s38, s30
    s_mov_b32 s15, 0
    s_mov_b32 s39, s31
    s_mov_b32 s16, 0
L_m_loop:
    s_add_u32 s62, s62, 3
    ds_read_b32 v26, v27
    s_waitcnt lgkmcnt(0)
    v_readfirstlane_b32 s12, v26
    s_lshl_b32 s50, s62, 5
    s_add_i32 s12, s12, s50
    s_load_dword s24, s[18:19], s4 glc
    s_load_dword s25, s[18:19], s5 glc
    s_load_dword s26, s[18:19], s6 glc
    s_load_dword s27, s[18:19], s7 glc
    s_load_dword s28, s[18:19], s8 glc
    s_load_dword s29, s[18:19], s9 glc
    s_load_dword s30, s[18:19], s10 glc
    s_load_dword s31, s[18:19], s11 glc
    s_sub_u32 s63, s63, 1
    s_cbranch_scc0 L_m_nopub
    s_mov_b32 s63, 2
    v_mov_b32 v26, s12
    global_store_dword v25, v26, s[18:19] sc1
L_m_nopub:
    s_mov_b32 s58, 3
L_h_idle2321:
    s_barrier
    s_sub_u32 s58, s58, 1
    s_cmp_lg_u32 s58, 0
    s_cbranch_scc1 L_h_idle2321
    s_waitcnt lgkmcnt(0)
    s_mov_b32 s51, 0
    s_sub_i32 s50, s24, s12
    s_cmp_lg_u32 s24, s32
    s_cselect_b32 s44, s50, s44
    s_mov_b32 s32, s24
    s_add_i32 s51, s51, s44
    s_sub_i32 s50, s25, s12
    s_cmp_lg_u32 s25, s33
    s_cselect_b32 s45, s50, s45
    s_mov_b32 s33, s25
    s_add_i32 s51, s51, s45
    s_sub_i32 s50, s26, s12
    s_cmp_lg_u32 s26, s34
    s_cselect_b32 s46, s50, s46
    s_mov_b32 s34, s26
    s_add_i32 s51, s51, s46
    s_sub_i32 s50, s27, s12
    s_cmp_lg_u32 s27, s35
    s_cselect_b32 s47, s50, s47
    s_mov_b32 s35, s27
    s_add_i32 s51, s51, s47
    s_sub_i32 s50, s28, s12
    s_cmp_lg_u32 s28, s36
    s_cselect_b32 s13, s50, s13
    s_mov_b32 s36, s28
    s_add_i32 s51, s51, s13
    s_sub_i32 s50, s29, s12
    s_cmp_lg_u32 s29, s37
    s_cselect_b32 s14, s50, s14
    s_mov_b32 s37, s29
    s_add_i32 s51, s51, s14
    s_sub_i32 s50, s30, s12
    s_cmp_lg_u32 s30, s38
    s_cselect_b32 s15, s50, s15
    s_mov_b32 s38, s30
    s_add_i32 s51, s51, s15
    s_sub_i32 s50, s31, s12
    s_cmp_lg_u32 s31, s39
    s_cselect_b32 s16, s50, s16
    s_mov_b32 s39, s31
    s_add_i32 s51, s51, s16
    s_ashr_i32 s51, s51, 3
    s_add_i32 s51, s51, -56
    s_sub_i32 s51, s51, s44
    s_max_i32 s51, s51, -256
    s_min_i32 s51, s51, 256
    s_cmp_gt_u32 s59, 44
    s_cselect_b32 s51, 0, s51
    v_mov_b32 v28, s51
    global_store_dword v24, v28, s[18:19]
    s_sub_u32 s59, s59, 1
    s_cmp_lg_u32 s59, 0
    s_cbranch_scc1 L_m_loop
    s_mov_b64 exec, -1
    s_branch L_m_done
L_m_idle:
    s_mov_b32 s58, 156
L_h_idle2384:
    s_barrier
    s_sub_u32 s58, s58, 1
    s_cmp_lg_u32 s58, 0
    s_cbranch_scc1 L_h_idle2384
L_m_done:
    s_mov_b32 s50, 0x07060500
    s_mov_b32 s51, 0x07060501
    s_mov_b32 s52, 0x07060502
    s_mov_b32 s53, 0x07060503
    s_mov_b32 vcc_lo, 0xffff0000
    s_mov_b32 vcc_hi, 0xffff0000
    s_mov_b32 s58, 15
L_h_idle2397:
    s_barrier
    s_sub_u32 s58, s58, 1
    s_cmp_lg_u32 s58, 0
    s_cbranch_scc1 L_h_idle2397
    s_barrier
    ds_read_b128 v[8:11], v1 offset:0
    ds_read_b128 v[12:15], v1 offset:64
    s_waitcnt lgkmcnt(1)
    v_mfma_f32_16x16x32_bf16 v[224:227], v[8:11], v[32:35], 0
    v_mfma_f32_16x16x32_bf16 v[228:231], v[8:11], v[36:39], 0
    v_mfma_f32_16x16x32_bf16 v[232:235], v[8:11], v[40:43], 0
    v_mfma_f32_16x16x32_bf16 v[236:239], v[8:11], v[44:47], 0
    v_mfma_f32_16x16x32_bf16 v[240:243], v[8:11], v[48:51], 0
    v_mfma_f32_16x16x32_bf16 v[244:247], v[8:11], v[52:55], 0
    v_mfma_f32_16x16x32_bf16 v[248:251], v[8:11], v[56:59], 0
    v_mfma_f32_16x16x32_bf16 v[252:255], v[8:11], v[60:63], 0
    s_waitcnt lgkmcnt(0)
    v_mfma_f32_16x16x32_bf16 v[224:227], v[12:15], v[64:67], v[224:227]
    v_mfma_f32_16x16x32_bf16 v[228:231], v[12:15], v[68:71], v[228:231]
    v_mfma_f32_16x16x32_bf16 v[232:235], v[12:15], v[72:75], v[232:235]
    v_mfma_f32_16x16x32_bf16 v[236:239], v[12:15], v[76:79], v[236:239]
    v_mfma_f32_16x16x32_bf16 v[240:243], v[12:15], v[80:83], v[240:243]
    v_mfma_f32_16x16x32_bf16 v[244:247], v[12:15], v[84:87], v[244:247]
    v_mfma_f32_16x16x32_bf16 v[248:251], v[12:15], v[88:91], v[248:251]
    v_mfma_f32_16x16x32_bf16 v[252:255], v[12:15], v[92:95], v[252:255]
    s_barrier
    ds_read_b128 v[8:11], v1 offset:128
    ds_read_b128 v[12:15], v1 offset:192
    s_waitcnt lgkmcnt(1)
    v_mfma_f32_16x16x32_bf16 v[224:227], v[8:11], v[96:99], v[224:227]
    v_mfma_f32_16x16x32_bf16 v[228:231], v[8:11], v[100:103], v[228:231]
    v_mfma_f32_16x16x32_bf16 v[232:235], v[8:11], v[104:107], v[232:235]
    v_mfma_f32_16x16x32_bf16 v[236:239], v[8:11], v[108:111], v[236:239]
    v_mfma_f32_16x16x32_bf16 v[240:243], v[8:11], v[112:115], v[240:243]
    v_mfma_f32_16x16x32_bf16 v[244:247], v[8:11], v[116:119], v[244:247]
    v_mfma_f32_16x16x32_bf16 v[248:251], v[8:11], v[120:123], v[248:251]
    v_mfma_f32_16x16x32_bf16 v[252:255], v[8:11], v[124:127], v[252:255]
    s_waitcnt lgkmcnt(0)
    v_mfma_f32_16x16x32_bf16 v[224:227], v[12:15], v[128:131], v[224:227]
    v_mfma_f32_16x16x32_bf16 v[228:231], v[12:15], v[132:135], v[228:231]
    v_mfma_f32_16x16x32_bf16 v[232:235], v[12:15], v[136:139], v[232:235]
    v_mfma_f32_16x16x32_bf16 v[236:239], v[12:15], v[140:143], v[236:239]
    v_mfma_f32_16x16x32_bf16 v[240:243], v[12:15], v[144:147], v[240:243]
    v_mfma_f32_16x16x32_bf16 v[244:247], v[12:15], v[148:151], v[244:247]
    v_mfma_f32_16x16x32_bf16 v[248:251], v[12:15], v[152:155], v[248:251]
    v_mfma_f32_16x16x32_bf16 v[252:255], v[12:15], v[156:159], v[252:255]
    s_barrier
    ds_read_b128 v[8:11], v1 offset:256
    ds_read_b128 v[12:15], v1 offset:320
    s_waitcnt lgkmcnt(1)
    v_mfma_f32_16x16x32_bf16 v[224:227], v[8:11], v[160:163], v[224:227]
    v_mfma_f32_16x16x32_bf16 v[228:231], v[8:11], v[164:167], v[228:231]
    v_mfma_f32_16x16x32_bf16 v[232:235], v[8:11], v[168:171], v[232:235]
    v_mfma_f32_16x16x32_bf16 v[236:239], v[8:11], v[172:175], v[236:239]
    v_mfma_f32_16x16x32_bf16 v[240:243], v[8:11], v[176:179], v[240:243]
    v_mfma_f32_16x16x32_bf16 v[244:247], v[8:11], v[180:183], v[244:247]
    v_mfma_f32_16x16x32_bf16 v[248:251], v[8:11], v[184:187], v[248:251]
    v_mfma_f32_16x16x32_bf16 v[252:255], v[8:11], v[188:191], v[252:255]
    s_waitcnt lgkmcnt(0)
    v_mfma_f32_16x16x32_bf16 v[224:227], v[12:15], v[192:195], v[224:227]
    v_mfma_f32_16x16x32_bf16 v[228:231], v[12:15], v[196:199], v[228:231]
    v_mfma_f32_16x16x32_bf16 v[232:235], v[12:15], v[200:203], v[232:235]
    v_mfma_f32_16x16x32_bf16 v[236:239], v[12:15], v[204:207], v[236:239]
    v_mfma_f32_16x16x32_bf16 v[240:243], v[12:15], v[208:211], v[240:243]
    v_mfma_f32_16x16x32_bf16 v[244:247], v[12:15], v[212:215], v[244:247]
    v_mfma_f32_16x16x32_bf16 v[248:251], v[12:15], v[216:219], v[248:251]
    v_mfma_f32_16x16x32_bf16 v[252:255], v[12:15], v[220:223], v[252:255]
    s_nop 4
    v_cndmask_b32 v20, v224, v240, vcc
    v_cndmask_b32 v21, v228, v244, vcc
    v_cndmask_b32 v22, v232, v248, vcc
    v_cndmask_b32 v23, v236, v252, vcc
    v_perm_b32 v24, v20, v7, s50
    v_perm_b32 v25, v21, v7, s51
    v_perm_b32 v26, v22, v7, s52
    v_perm_b32 v27, v23, v7, s53
    s_mov_b32 exec_hi, 0
    buffer_store_dwordx4 v[24:27], v6, s[40:43], 0 offen sc1
    s_waitcnt vmcnt(0)
    s_barrier
L_end:
    s_endpgm
.section .rodata,"a"
.p2align 6
.amdhsa_kernel standalone__mha_block_cached__sampling_kernel
  .amdhsa_next_free_vgpr 256
  .amdhsa_next_free_sgpr 96
  .amdhsa_accum_offset 256
  .amdhsa_group_segment_fixed_size 0
  .amdhsa_kernarg_size 64
  .amdhsa_user_sgpr_count 2
  .amdhsa_user_sgpr_kernarg_segment_ptr 1
  .amdhsa_system_sgpr_workgroup_id_x 1
  .amdhsa_float_denorm_mode_32 3
.end_amdhsa_kernel
```
